```python
import torch

def _softmax(x, axis=-1):
    return torch.softmax(x, dim=axis)
def _gelu(x):
    return torch.nn.functional.gelu(x, approximate="tanh")
def _silu(x):
    return torch.nn.functional.silu(x)
def _sigmoid(x):
    return torch.sigmoid(x)
def _layernorm(x, axis=-1, eps=1e-5):
    m = x.mean(dim=axis, keepdim=True)
    v = x.var(dim=axis, keepdim=True, unbiased=False)
    return (x - m) / torch.sqrt(v + eps)
def _scatter_add(tgt, idx, src, axis=0):
    return tgt.clone().index_add_(axis, idx, src)
def _segment_sum(src, seg, n):
    out = torch.zeros((n,) + src.shape[1:], dtype=src.dtype)
    return out.index_add_(0, seg, src)
def _pad(x, pw):
    flat = tuple(v for pair in reversed(pw) for v in pair)
    return torch.nn.functional.pad(x, flat)

kernel_name = 'standalone__qk_norm__prompt'

def setup_inputs():

    _w = (lambda a: (lambda t: t.to(torch.bfloat16) if t.is_floating_point() else t)(torch.as_tensor(a)))
    B, H, S, D = 4, 16, 2048, 448
    Dh = D // H
    return {
        "q": _w((lambda *s: torch.randn(*s, dtype=torch.bfloat16) * 0.05)(B, H, S, Dh)),
        "k": _w((lambda *s: torch.randn(*s, dtype=torch.bfloat16) * 0.05)(B, H, S, Dh)),
        "v": _w((lambda *s: torch.randn(*s, dtype=torch.bfloat16) * 0.8)(B, H, S, Dh)),
        "t": _w(torch.abs((lambda *s: torch.randn(*s, dtype=torch.bfloat16) * 0.8)(H)) + 1.0),
    }

def reference(q, k, v, t):
    eps = 1e-6
    qn = q / (torch.sqrt((q * q).sum(axis=-1, keepdims=True)) + eps)
    kn = k / (torch.sqrt((k * k).sum(axis=-1, keepdims=True)) + eps)
    logits = torch.einsum('bhqd,bhkd->bhqk', qn, kn) * t[None, :, None, None]
    attn = _softmax(logits, axis=-1)
    return torch.einsum('bhqk,bhkd->bhqd', attn, v)
```

```asm
; @launch grid=(256,1,1) block=(768,1,1) lds=159808
.amdgcn_target "amdgcn-amd-amdhsa--gfx950"
.text
.globl standalone__qk_norm__prompt_kernel
.p2align 12
.p2align 8
.type standalone__qk_norm__prompt_kernel,@function
standalone__qk_norm__prompt_kernel:
    s_cmp_ge_u32 s2, 256
    s_cbranch_scc1 L_end
    s_mov_b32 s50, 0
L_top:
    s_load_dwordx8 s[4:11], s[0:1], 0
    s_load_dwordx4 s[12:15], s[0:1], 32
    s_load_dwordx2 s[58:59], s[0:1], 48
    v_lshrrev_b32 v1, 6, v0
    s_and_b32 s19, s2, 7
    s_lshl_b32 s19, s19, 3
    s_lshr_b32 s18, s2, 5
    v_readfirstlane_b32 s16, v1
    s_mov_b32 s52, s0
    s_and_b32 s53, s1, 0xffff
    s_mov_b32 s54, 0
    s_mov_b32 s55, 0x00020000
    s_mov_b32 s20, s0
    s_and_b32 s21, s1, 0xffff
    s_mov_b32 s22, 0
    s_mov_b32 s23, 0x00020000
    s_mov_b32 s24, s0
    s_and_b32 s25, s1, 0xffff
    s_mov_b32 s26, 0
    s_mov_b32 s27, 0x00020000
    s_mov_b32 s28, s0
    s_and_b32 s29, s1, 0xffff
    s_mov_b32 s30, 0
    s_mov_b32 s31, 0x00020000
    s_mov_b32 s96, s0
    s_and_b32 s97, s1, 0xffff
    s_mov_b32 s98, 0
    s_mov_b32 s99, 0x00020000
    s_mov_b32 s60, s0
    s_and_b32 s61, s1, 0xffff
    s_mov_b32 s62, 0
    s_mov_b32 s63, 0x00020000
    s_mov_b32 s36, 7
    s_mov_b64 vcc, -1
    s_cmp_eq_u32 s16, 4
    s_cbranch_scc1 L_stubA
    s_cmp_eq_u32 s16, 5
    s_cbranch_scc1 L_ustub
    s_cmp_eq_u32 s16, 6
    s_cbranch_scc1 L_vstub
    s_cmp_eq_u32 s16, 7
    s_cbranch_scc1 L_cand7
L_r1done:
    s_add_u32 s33, s19, s18
    s_lshr_b32 s38, s2, 3
    s_and_b32 s38, s38, 3
    s_mul_i32 s37, s33, 114688
    v_and_b32 v151, 63, v0
    s_and_b32 s44, s16, 3
    s_lshl_b32 s18, s38, 3
    s_add_u32 s18, s18, s16
    s_mul_i32 s34, s18, 3584
    s_lshl_b32 s47, s18, 12
    s_mul_i32 s40, s44, 3584
    s_and_b32 s42, s33, 14
    s_lshl_b32 s42, s42, 1
    v_lshlrev_b32 v142, 4, v151
    v_mul_u32_u24 v141, 56, v151
    s_mul_i32 s43, s44, 7168
    s_add_u32 s43, s43, 131072
    s_lshl_b32 s49, s44, 12
    s_add_u32 s45, s49, 16384
    s_waitcnt lgkmcnt(0)
    s_add_u32 s52, s4, s37
    s_addc_u32 s53, s5, 0
    s_and_b32 s53, s53, 0xffff
    s_mov_b32 s54, 114688
    s_mov_b32 s55, 0x00020000
    s_cmp_ge_u32 s16, 4
    s_cbranch_scc1 L_noq
    s_lshl_b32 s18, s16, 12
    s_add_u32 s18, s18, 32768
    s_mov_b32 m0, s18
    s_nop 0
    buffer_load_dwordx4 v142, s[52:55], s34 offen offset:0 lds
    buffer_load_dwordx4 v142, s[52:55], s34 offen offset:1024 lds
    buffer_load_dwordx4 v142, s[52:55], s34 offen offset:2048 lds
    s_mov_b32 exec_hi, 0
    buffer_load_dwordx4 v142, s[52:55], s34 offen offset:3072 lds
    s_mov_b32 exec_hi, -1
    v_add_u32 v143, s18, v141
L_noq:
    s_add_u32 s20, s6, s37
    s_addc_u32 s21, s7, 0
    s_and_b32 s21, s21, 0xffff
    s_mov_b32 s22, 114688
    s_mov_b32 s23, 0x00020000
    s_add_u32 s24, s8, s37
    s_addc_u32 s25, s9, 0
    s_and_b32 s25, s25, 0xffff
    s_mov_b32 s26, 114688
    s_mov_b32 s27, 0x00020000
    s_load_dword s17, s[10:11], s42
    s_load_dwordx8 s[4:11], s[10:11], 0
    s_cmp_lt_u32 s16, 4
    s_cbranch_scc1 L_loaded
    s_cmp_lt_u32 s16, 8
    s_cbranch_scc1 L_v0
    s_setprio 3
    s_mov_b32 m0, s49
    s_nop 0
    buffer_load_dwordx4 v142, s[20:23], s40 offen offset:0 lds
    buffer_load_dwordx4 v142, s[20:23], s40 offen offset:1024 lds
    buffer_load_dwordx4 v142, s[20:23], s40 offen offset:2048 lds
    s_mov_b32 exec_hi, 0
    buffer_load_dwordx4 v142, s[20:23], s40 offen offset:3072 lds
    s_mov_b32 exec_hi, -1
    s_xor_b32 s18, s50, 1
L_v0:
    s_cmp_lt_u32 s16, 8
    s_cselect_b32 s18, s50, s18
    s_cmp_lg_u32 s18, 0
    s_cbranch_scc1 L_loaded
    s_mov_b32 m0, s45
    s_nop 0
    buffer_load_dwordx4 v142, s[24:27], s40 offen offset:0 lds
    buffer_load_dwordx4 v142, s[24:27], s40 offen offset:1024 lds
    buffer_load_dwordx4 v142, s[24:27], s40 offen offset:2048 lds
    s_mov_b32 exec_hi, 0
    buffer_load_dwordx4 v142, s[24:27], s40 offen offset:3072 lds
    s_mov_b32 exec_hi, -1
L_loaded:
    s_add_u32 s28, s12, s37
    s_addc_u32 s29, s13, 0
    s_and_b32 s29, s29, 0xffff
    s_mov_b32 s30, 114688
    s_mov_b32 s31, 0x00020000
    s_mov_b32 s96, s14
    s_and_b32 s97, s15, 0xffff
    s_mov_b32 s98, 256
    s_mov_b32 s99, 0x00020000
    s_lshl_b32 s18, s33, 19
    s_add_u32 s60, s58, s18
    s_addc_u32 s61, s59, 0
    s_and_b32 s61, s61, 0xffff
    s_mov_b32 s62, 524288
    s_mov_b32 s63, 0x00020000
    s_mov_b32 s14, s33
    s_mov_b32 s15, s38
    s_mov_b32 s3, 0xffff0000
    s_mov_b32 s95, 0x3f803f80
    s_mov_b32 s36, 0
    v_lshrrev_b32 v24, 5, v151
    v_and_b32 v25, 31, v151
    v_lshlrev_b32 v27, 4, v25
    v_lshl_add_u32 v145, v24, 11, v27
    v_mul_u32_u24 v23, 56, v25
    v_lshl_add_u32 v23, v24, 3, v23
    s_lshl_b32 s18, s16, 12
    v_add_u32 v3, s18, v23
    v_add_u32 v144, s18, v142
    v_bfe_u32 v25, v151, 2, 2
    v_lshl_add_u32 v25, v24, 2, v25
    v_mul_u32_u24 v25, 56, v25
    v_bfe_u32 v26, v151, 4, 1
    v_and_b32 v27, 3, v151
    v_lshl_add_u32 v26, v26, 2, v27
    v_lshl_add_u32 v150, v26, 3, v25
    v_mov_b32 v1, v142
    s_mov_b64 vcc, 0
    s_lshl_b32 s18, s14, 2
    v_mov_b32 v146, s18
    v_mov_b32 v135, 0x3c000000
    v_mov_b32 v136, 0x3c00
    v_mov_b32 v148, 159744
    v_mov_b32 v137, 159744
    s_mov_b32 s42, 0
    s_cmp_ge_u32 s16, 8
    s_cbranch_scc1 L_hdry
    s_cmp_lt_u32 s16, 2
    s_cbranch_scc1 L_unit
L_dry:
    s_waitcnt lgkmcnt(0)
    s_and_b32 s18, s14, 1
    s_lshl_b32 s18, s18, 4
    s_lshr_b32 s17, s17, s18
    s_and_b32 s18, s17, 0x7fff
    s_cmp_gt_u32 s18, 16431
    s_cselect_b32 s32, 1, s50
    s_cmp_gt_u32 s18, 0x4130
    s_cselect_b32 s32, 2, s32
    s_lshr_b32 s51, s32, 1
    s_or_b32 s51, s51, s50
    s_mov_b32 s36, 1
    s_lshl_b32 s17, s17, 16
    v_mov_b32 v134, s17
    v_mul_f32 v134, 0x3fb8aa3b, v134
    v_or_b32 v136, 0x80000000, v134
    v_cvt_f16_f32 v136, v136
    v_mul_f32 v135, 0x43000000, v134
    v_and_b32 v136, 0xffff, v136
    s_cmp_eq_u32 s32, 1
    s_cbranch_scc1 L_qs
    v_mov_b32 v135, 0x43000000
    v_mov_b32 v136, 0
    s_cmp_eq_u32 s32, 2
    s_cbranch_scc1 L_qs
    v_mul_f32 v135, 0x3c000000, v134
    v_mov_b32 v136, 0x3c14
    s_cmp_gt_u32 s18, 0x3fb0
    s_cbranch_scc1 L_qs
    v_mul_f32 v135, 0x3c800000, v134
    v_mov_b32 v136, 0x3c0c
L_qs:
    s_cmp_lt_u32 s16, 4
    s_cbranch_scc1 L_qsA
    buffer_load_dwordx4 v[52:55], v141, s[52:55], s34 offen offset:0
    buffer_load_dwordx4 v[56:59], v141, s[52:55], s34 offen offset:16
    buffer_load_dwordx4 v[60:63], v141, s[52:55], s34 offen offset:32
    buffer_load_dwordx2 v[64:65], v141, s[52:55], s34 offen offset:48
    s_mov_b32 s42, 1
    s_cmp_eq_u32 s50, 0
    s_cbranch_scc1 L_bv
L_bvdone:
    s_waitcnt lgkmcnt(0)
    s_barrier
    s_mov_b64 vcc, -1
    s_cmp_eq_u32 s32, 1
    s_cbranch_scc1 L_r2f
    s_cmp_eq_u32 s16, 4
    s_cbranch_scc1 L_cand112
    s_cmp_eq_u32 s16, 5
    s_cbranch_scc1 L_stubB
    s_cmp_eq_u32 s16, 6
    s_cbranch_scc1 L_cand76
    s_cmp_eq_u32 s16, 7
    s_cbranch_scc1 L_cand30
    s_branch L_r2done
L_qsA:
    s_cmp_eq_u32 s32, 1
    s_cbranch_scc0 L_qs2
    s_mov_b64 vcc, -1
L_r2f:
    s_cmp_eq_u32 s16, 0
    s_cbranch_scc1 L_fast
    s_cmp_eq_u32 s16, 1
    s_cbranch_scc1 L_cand142
    s_cmp_eq_u32 s16, 2
    s_cbranch_scc1 L_cand164
    s_cmp_eq_u32 s16, 3
    s_cbranch_scc1 L_cand193
    s_cmp_eq_u32 s16, 4
    s_cbranch_scc1 L_cand222
    s_cmp_eq_u32 s16, 5
    s_cbranch_scc1 L_stubB
    s_cmp_eq_u32 s16, 6
    s_cbranch_scc1 L_cand249
    s_cmp_eq_u32 s16, 7
    s_cbranch_scc1 L_padd
    s_branch L_r2done
L_tret:
    s_cmp_eq_u32 s36, 7
    s_cbranch_scc1 L_r1done
L_r2done:
    s_mov_b64 vcc, 0
L_qs2:
    s_waitcnt vmcnt(0)
    s_cmp_lt_u32 s16, 4
    s_cbranch_scc1 L_hunit
    v_mov_b32 v4, v52
    v_mov_b32 v5, v53
    v_mov_b32 v6, v54
    v_mov_b32 v7, v55
    v_mov_b32 v8, v56
    v_mov_b32 v9, v57
    v_mov_b32 v10, v58
    v_mov_b32 v11, v59
    v_mov_b32 v12, v60
    v_mov_b32 v13, v61
    v_mov_b32 v14, v62
    v_mov_b32 v15, v63
    v_mov_b32 v16, v64
    v_mov_b32 v17, v65
    s_branch L_unit
L_bv:
    v_and_b32 v24, 31, v151
    v_lshrrev_b32 v25, 5, v151
    v_bfe_u32 v26, v24, 2, 1
    v_bfe_u32 v27, v24, 3, 1
    v_and_b32 v28, 3, v24
    v_lshl_add_u32 v27, v27, 2, v28
    v_and_b32 v28, 1, v27
    v_lshlrev_b32 v28, 4, v28
    v_mov_b32 v29, 0x3f80
    v_lshlrev_b32 v29, v28, v29
    v_cmp_eq_u32 vcc, v25, v26
    v_cndmask_b32 v29, 0, v29, vcc
    v_lshrrev_b32 v27, 1, v27
    v_lshrrev_b32 v28, 4, v24
    v_lshl_add_u32 v27, v28, 2, v27
    v_cmp_eq_u32 vcc, 0, v27
    v_cndmask_b32 v116, 0, v29, vcc
    v_cmp_eq_u32 vcc, 1, v27
    v_cndmask_b32 v117, 0, v29, vcc
    v_cmp_eq_u32 vcc, 2, v27
    v_cndmask_b32 v118, 0, v29, vcc
    v_cmp_eq_u32 vcc, 3, v27
    v_cndmask_b32 v119, 0, v29, vcc
    v_cmp_eq_u32 vcc, 4, v27
    v_cndmask_b32 v120, 0, v29, vcc
    v_cmp_eq_u32 vcc, 5, v27
    v_cndmask_b32 v121, 0, v29, vcc
    v_cmp_eq_u32 vcc, 6, v27
    v_cndmask_b32 v122, 0, v29, vcc
    v_cmp_eq_u32 vcc, 7, v27
    v_cndmask_b32 v123, 0, v29, vcc
    v_cmp_gt_u32 vcc, 28, v24
    s_mov_b64 s[92:93], vcc
    v_cmp_eq_u32 vcc, 28, v24
    s_cmp_eq_u32 s32, 0
    s_cselect_b32 s18, 0x3c003c00, s95
    v_mov_b32 v29, s18
    v_cndmask_b32 v29, 0, v29, vcc
    v_mov_b32 v100, v29
    v_mov_b32 v101, v29
    v_mov_b32 v102, v29
    v_mov_b32 v103, v29
    v_mov_b32 v104, v29
    v_mov_b32 v105, v29
    v_mov_b32 v106, v29
    v_mov_b32 v107, v29
    v_mov_b32 v108, v29
    v_mov_b32 v109, v29
    v_mov_b32 v110, v29
    v_mov_b32 v111, v29
    v_mov_b32 v112, v29
    v_mov_b32 v113, v29
    v_mov_b32 v114, v29
    v_mov_b32 v115, v29
    s_mov_b64 vcc, 0
    v_add_u32 v143, s49, v141
    v_add_u32 v140, s49, v145
    s_add_u32 s18, s49, 16384
    v_add_u32 v156, s18, v150
    v_add_u32 v157, s18, v142
    s_waitcnt vmcnt(4)
    s_branch L_vunit
L_hdry:
    v_mov_b32 v8, 0
    v_mov_b32 v9, 0
    v_mov_b32 v10, 0
    v_mov_b32 v11, 0
    ds_write_b128 v148, v[8:11]
    ds_write_b128 v148, v[8:11] offset:16
    ds_write_b128 v148, v[8:11] offset:32
    ds_write_b32 v148, v8 offset:48
    s_cmp_lg_u32 s50, 0
    s_cbranch_scc1 L_nozr
    ds_write_b32 v148, v8 offset:52
L_nozr:
    v_and_b32 v24, 31, v151
    v_lshrrev_b32 v25, 5, v151
    v_bfe_u32 v26, v24, 2, 1
    v_bfe_u32 v27, v24, 3, 1
    v_and_b32 v28, 3, v24
    v_lshl_add_u32 v27, v27, 2, v28
    v_and_b32 v28, 1, v27
    v_lshlrev_b32 v28, 4, v28
    v_mov_b32 v29, 0x3f80
    v_lshlrev_b32 v29, v28, v29
    v_cmp_eq_u32 vcc, v25, v26
    v_cndmask_b32 v29, 0, v29, vcc
    v_lshrrev_b32 v27, 1, v27
    v_lshrrev_b32 v28, 4, v24
    v_lshl_add_u32 v27, v28, 2, v27
    v_cmp_eq_u32 vcc, 0, v27
    v_cndmask_b32 v116, 0, v29, vcc
    v_cmp_eq_u32 vcc, 1, v27
    v_cndmask_b32 v117, 0, v29, vcc
    v_cmp_eq_u32 vcc, 2, v27
    v_cndmask_b32 v118, 0, v29, vcc
    v_cmp_eq_u32 vcc, 3, v27
    v_cndmask_b32 v119, 0, v29, vcc
    v_cmp_eq_u32 vcc, 4, v27
    v_cndmask_b32 v120, 0, v29, vcc
    v_cmp_eq_u32 vcc, 5, v27
    v_cndmask_b32 v121, 0, v29, vcc
    v_cmp_eq_u32 vcc, 6, v27
    v_cndmask_b32 v122, 0, v29, vcc
    v_cmp_eq_u32 vcc, 7, v27
    v_cndmask_b32 v123, 0, v29, vcc
    v_cmp_gt_u32 vcc, 28, v24
    s_mov_b64 s[92:93], vcc
    v_cmp_eq_u32 vcc, 28, v24
    s_waitcnt lgkmcnt(0)
    s_and_b32 s18, s14, 1
    s_lshl_b32 s18, s18, 4
    s_lshr_b32 s17, s17, s18
    s_and_b32 s18, s17, 0x7fff
    s_cmp_gt_u32 s18, 16431
    s_cselect_b32 s32, 1, s50
    s_cmp_gt_u32 s18, 0x4130
    s_cselect_b32 s32, 2, s32
    s_lshr_b32 s51, s32, 1
    s_or_b32 s51, s51, s50
    s_lshr_b32 s19, s95, 16
    s_cmp_eq_u32 s32, 0
    s_cselect_b32 s18, s19, 0x3c00
    v_mov_b32 v136, s18
    s_cselect_b32 s18, 0x3c003c00, s95
    v_mov_b32 v29, s18
    v_cndmask_b32 v29, 0, v29, vcc
    v_mov_b32 v100, v29
    v_mov_b32 v101, v29
    v_mov_b32 v102, v29
    v_mov_b32 v103, v29
    v_mov_b32 v104, v29
    v_mov_b32 v105, v29
    v_mov_b32 v106, v29
    v_mov_b32 v107, v29
    v_mov_b32 v108, v29
    v_mov_b32 v109, v29
    v_mov_b32 v110, v29
    v_mov_b32 v111, v29
    v_mov_b32 v112, v29
    v_mov_b32 v113, v29
    v_mov_b32 v114, v29
    v_mov_b32 v115, v29
    s_mov_b64 vcc, 0
    s_lshr_b32 s41, s32, 1
    s_lshl_b32 s41, s41, 2
    s_add_u32 s41, s41, 4
    s_mov_b32 s42, 1
    s_mov_b32 s36, 1
    v_add_u32 v143, s49, v141
    v_add_u32 v140, s49, v145
    s_add_u32 s18, s49, 16384
    v_add_u32 v156, s18, v150
    v_add_u32 v157, s18, v142
    s_cmp_eq_u32 s50, 0
    s_cbranch_scc1 L_k0w
    s_waitcnt vmcnt(4)
    s_branch L_hunit
L_k0w:
    s_waitcnt vmcnt(0)
    s_branch L_hunit
L_stubA:
    s_branch L_tret
L_hpost:
    s_bitcmp1_b32 s42, 0
    s_cbranch_scc0 L_nolds
    ds_write_b128 v140, v[84:87] offset:0
    ds_write_b128 v140, v[88:91] offset:512
    ds_write_b128 v140, v[92:95] offset:1024
    ds_write_b128 v140, v[96:99] offset:1536
L_nolds:
    s_bitcmp1_b32 s42, 1
    s_cbranch_scc0 L_nopub
    buffer_store_dwordx4 v[84:87], v145, s[60:63], s47 offen offset:0 sc1
    buffer_store_dwordx4 v[88:91], v145, s[60:63], s47 offen offset:512 sc1
    buffer_store_dwordx4 v[92:95], v145, s[60:63], s47 offen offset:1024 sc1
    buffer_store_dwordx4 v[96:99], v145, s[60:63], s47 offen offset:1536 sc1
L_nopub:
    s_cmp_eq_u32 s36, 1
    s_cbranch_scc0 L_hp2
    s_cmp_eq_u32 s50, 0
    s_cbranch_scc1 L_c0done
    s_waitcnt vmcnt(0)
    s_branch L_vunit
L_hp2:
    s_cmp_eq_u32 s36, 2
    s_cbranch_scc0 L_hp3
    s_add_u32 s57, s57, 3584
    s_add_u32 s45, s39, 4096
    s_mov_b32 m0, s45
    s_nop 0
    buffer_load_dwordx4 v142, s[20:23], s57 offen offset:0 lds
    buffer_load_dwordx4 v142, s[20:23], s57 offen offset:1024 lds
    buffer_load_dwordx4 v142, s[20:23], s57 offen offset:2048 lds
    s_mov_b32 exec_hi, 0
    buffer_load_dwordx4 v142, s[20:23], s57 offen offset:3072 lds
    s_mov_b32 exec_hi, -1
    s_add_u32 s45, s39, 20480
    s_mov_b32 m0, s45
    s_nop 0
    buffer_load_dwordx4 v142, s[24:27], s57 offen offset:0 lds
    buffer_load_dwordx4 v142, s[24:27], s57 offen offset:1024 lds
    buffer_load_dwordx4 v142, s[24:27], s57 offen offset:2048 lds
    s_mov_b32 exec_hi, 0
    buffer_load_dwordx4 v142, s[24:27], s57 offen offset:3072 lds
    s_mov_b32 exec_hi, -1
    s_waitcnt vmcnt(16)
    s_branch L_vunit
L_hp3:
    s_cmp_eq_u32 s36, 5
    s_cbranch_scc0 L_hp6
    s_waitcnt vmcnt(16)
    s_branch L_vunit
L_hp6:
    s_cmp_eq_u32 s36, 6
    s_cbranch_scc0 L_hp4
    s_waitcnt vmcnt(8)
    s_branch L_vunit
L_hp4:
    s_waitcnt vmcnt(4)
L_vunit:
    ds_read_b64_tr_b16 v[4:5], v156 offset:0
    ds_read_b64_tr_b16 v[6:7], v156 offset:448
    ds_read_b64_tr_b16 v[8:9], v156 offset:896
    ds_read_b64_tr_b16 v[10:11], v156 offset:1344
    ds_read_b64_tr_b16 v[12:13], v156 offset:1792
    ds_read_b64_tr_b16 v[14:15], v156 offset:2240
    ds_read_b64_tr_b16 v[16:17], v156 offset:2688
    ds_read_b64_tr_b16 v[18:19], v156 offset:3136
    s_cmp_lg_u32 s32, 0
    s_cbranch_scc1 L_vraw
    s_waitcnt lgkmcnt(4)
    v_mfma_f32_32x32x16_bf16 v[20:35], v[116:119], v[4:7], 0
    v_mfma_f32_32x32x16_bf16 v[20:35], v[120:123], v[8:11], v[20:35]
    s_waitcnt lgkmcnt(0)
    v_mfma_f32_32x32x16_bf16 v[36:51], v[116:119], v[12:15], 0
    v_mfma_f32_32x32x16_bf16 v[36:51], v[120:123], v[16:19], v[36:51]
L_vstub:
    s_cbranch_vccnz L_tret
    s_mov_b64 exec, s[92:93]
    s_nop 7
    v_cvt_pk_f16_f32 v100, v20, v21
    v_cvt_pk_f16_f32 v101, v22, v23
    v_cvt_pk_f16_f32 v102, v24, v25
    v_cvt_pk_f16_f32 v103, v26, v27
    v_cvt_pk_f16_f32 v104, v28, v29
    v_cvt_pk_f16_f32 v105, v30, v31
    v_cvt_pk_f16_f32 v106, v32, v33
    v_cvt_pk_f16_f32 v107, v34, v35
    s_nop 7
    v_cvt_pk_f16_f32 v108, v36, v37
    v_cvt_pk_f16_f32 v109, v38, v39
    v_cvt_pk_f16_f32 v110, v40, v41
    v_cvt_pk_f16_f32 v111, v42, v43
    v_cvt_pk_f16_f32 v112, v44, v45
    v_cvt_pk_f16_f32 v113, v46, v47
    v_cvt_pk_f16_f32 v114, v48, v49
    v_cvt_pk_f16_f32 v115, v50, v51
    s_branch L_vdone
L_vraw:
    s_waitcnt lgkmcnt(0)
    s_mov_b64 exec, s[92:93]
    v_mov_b32 v100, v4
    v_mov_b32 v101, v5
    v_mov_b32 v102, v6
    v_mov_b32 v103, v7
    v_mov_b32 v104, v8
    v_mov_b32 v105, v9
    v_mov_b32 v106, v10
    v_mov_b32 v107, v11
    v_mov_b32 v108, v12
    v_mov_b32 v109, v13
    v_mov_b32 v110, v14
    v_mov_b32 v111, v15
    v_mov_b32 v112, v16
    v_mov_b32 v113, v17
    v_mov_b32 v114, v18
    v_mov_b32 v115, v19
L_vdone:
    s_mov_b64 exec, -1
    s_bitcmp1_b32 s42, 0
    s_cbranch_scc0 L_vnolds
    ds_write_b128 v157, v[100:103] offset:0
    ds_write_b128 v157, v[104:107] offset:1024
    ds_write_b128 v157, v[108:111] offset:2048
    ds_write_b128 v157, v[112:115] offset:3072
L_vnolds:
    s_bitcmp1_b32 s42, 1
    s_cbranch_scc0 L_vnopub
    buffer_store_dwordx4 v[100:103], v142, s[60:63], s94 offen offset:0 sc1
    buffer_store_dwordx4 v[104:107], v142, s[60:63], s94 offen offset:1024 sc1
    buffer_store_dwordx4 v[108:111], v142, s[60:63], s94 offen offset:2048 sc1
    buffer_store_dwordx4 v[112:115], v142, s[60:63], s94 offen offset:3072 sc1
L_vnopub:
    s_cmp_lt_u32 s16, 8
    s_cbranch_scc1 L_bvdone
    s_cmp_eq_u32 s36, 1
    s_cbranch_scc0 L_vp2
L_c0done:
    s_waitcnt lgkmcnt(0)
    s_barrier
    s_add_u32 s40, s40, 14336
    s_add_u32 s49, s49, 32768
    s_mov_b32 m0, s49
    s_nop 0
    buffer_load_dwordx4 v142, s[20:23], s40 offen offset:0 lds
    buffer_load_dwordx4 v142, s[20:23], s40 offen offset:1024 lds
    buffer_load_dwordx4 v142, s[20:23], s40 offen offset:2048 lds
    s_mov_b32 exec_hi, 0
    buffer_load_dwordx4 v142, s[20:23], s40 offen offset:3072 lds
    s_mov_b32 exec_hi, -1
    s_add_u32 s45, s49, 16384
    s_mov_b32 m0, s45
    s_nop 0
    buffer_load_dwordx4 v142, s[24:27], s40 offen offset:0 lds
    buffer_load_dwordx4 v142, s[24:27], s40 offen offset:1024 lds
    buffer_load_dwordx4 v142, s[24:27], s40 offen offset:2048 lds
    s_mov_b32 exec_hi, 0
    buffer_load_dwordx4 v142, s[24:27], s40 offen offset:3072 lds
    s_mov_b32 exec_hi, -1
    s_lshr_b32 s39, s44, 1
    s_lshl_b32 s39, s39, 15
    s_and_b32 s19, s44, 1
    s_lshl_b32 s19, s19, 13
    s_add_u32 s39, s39, s19
    s_add_u32 s39, s39, 65536
    s_mul_i32 s57, s44, 7168
    s_add_u32 s57, s57, 28672
    s_mov_b32 m0, s39
    s_nop 0
    buffer_load_dwordx4 v142, s[20:23], s57 offen offset:0 lds
    buffer_load_dwordx4 v142, s[20:23], s57 offen offset:1024 lds
    buffer_load_dwordx4 v142, s[20:23], s57 offen offset:2048 lds
    s_mov_b32 exec_hi, 0
    buffer_load_dwordx4 v142, s[20:23], s57 offen offset:3072 lds
    s_mov_b32 exec_hi, -1
    s_add_u32 s45, s39, 16384
    s_mov_b32 m0, s45
    s_nop 0
    buffer_load_dwordx4 v142, s[24:27], s57 offen offset:0 lds
    buffer_load_dwordx4 v142, s[24:27], s57 offen offset:1024 lds
    buffer_load_dwordx4 v142, s[24:27], s57 offen offset:2048 lds
    s_mov_b32 exec_hi, 0
    buffer_load_dwordx4 v142, s[24:27], s57 offen offset:3072 lds
    s_mov_b32 exec_hi, -1
    v_add_u32 v143, s49, v141
    v_add_u32 v140, s49, v145
    s_add_u32 s18, s49, 16384
    v_add_u32 v156, s18, v150
    v_add_u32 v157, s18, v142
    s_waitcnt lgkmcnt(0)
    s_mov_b32 s12, 0
    s_mov_b32 s13, 0
    s_bfe_u32 s18, s4, 0xf0000
    s_cmp_le_u32 s18, 16431
    s_cselect_b32 s19, 1, 0
    s_or_b32 s12, s12, s19
    s_cmp_le_u32 s18, 0x4130
    s_cselect_b32 s19, 1, 0
    s_or_b32 s13, s13, s19
    s_bfe_u32 s18, s4, 0xf0010
    s_cmp_le_u32 s18, 16431
    s_cselect_b32 s19, 2, 0
    s_or_b32 s12, s12, s19
    s_cmp_le_u32 s18, 0x4130
    s_cselect_b32 s19, 2, 0
    s_or_b32 s13, s13, s19
    s_bfe_u32 s18, s5, 0xf0000
    s_cmp_le_u32 s18, 16431
    s_cselect_b32 s19, 4, 0
    s_or_b32 s12, s12, s19
    s_cmp_le_u32 s18, 0x4130
    s_cselect_b32 s19, 4, 0
    s_or_b32 s13, s13, s19
    s_bfe_u32 s18, s5, 0xf0010
    s_cmp_le_u32 s18, 16431
    s_cselect_b32 s19, 8, 0
    s_or_b32 s12, s12, s19
    s_cmp_le_u32 s18, 0x4130
    s_cselect_b32 s19, 8, 0
    s_or_b32 s13, s13, s19
    s_bfe_u32 s18, s6, 0xf0000
    s_cmp_le_u32 s18, 16431
    s_cselect_b32 s19, 16, 0
    s_or_b32 s12, s12, s19
    s_cmp_le_u32 s18, 0x4130
    s_cselect_b32 s19, 16, 0
    s_or_b32 s13, s13, s19
    s_bfe_u32 s18, s6, 0xf0010
    s_cmp_le_u32 s18, 16431
    s_cselect_b32 s19, 32, 0
    s_or_b32 s12, s12, s19
    s_cmp_le_u32 s18, 0x4130
    s_cselect_b32 s19, 32, 0
    s_or_b32 s13, s13, s19
    s_bfe_u32 s18, s7, 0xf0000
    s_cmp_le_u32 s18, 16431
    s_cselect_b32 s19, 64, 0
    s_or_b32 s12, s12, s19
    s_cmp_le_u32 s18, 0x4130
    s_cselect_b32 s19, 64, 0
    s_or_b32 s13, s13, s19
    s_bfe_u32 s18, s7, 0xf0010
    s_cmp_le_u32 s18, 16431
    s_cselect_b32 s19, 128, 0
    s_or_b32 s12, s12, s19
    s_cmp_le_u32 s18, 0x4130
    s_cselect_b32 s19, 128, 0
    s_or_b32 s13, s13, s19
    s_bfe_u32 s18, s8, 0xf0000
    s_cmp_le_u32 s18, 16431
    s_cselect_b32 s19, 256, 0
    s_or_b32 s12, s12, s19
    s_cmp_le_u32 s18, 0x4130
    s_cselect_b32 s19, 256, 0
    s_or_b32 s13, s13, s19
    s_bfe_u32 s18, s8, 0xf0010
    s_cmp_le_u32 s18, 16431
    s_cselect_b32 s19, 512, 0
    s_or_b32 s12, s12, s19
    s_cmp_le_u32 s18, 0x4130
    s_cselect_b32 s19, 512, 0
    s_or_b32 s13, s13, s19
    s_bfe_u32 s18, s9, 0xf0000
    s_cmp_le_u32 s18, 16431
    s_cselect_b32 s19, 1024, 0
    s_or_b32 s12, s12, s19
    s_cmp_le_u32 s18, 0x4130
    s_cselect_b32 s19, 1024, 0
    s_or_b32 s13, s13, s19
    s_bfe_u32 s18, s9, 0xf0010
    s_cmp_le_u32 s18, 16431
    s_cselect_b32 s19, 2048, 0
    s_or_b32 s12, s12, s19
    s_cmp_le_u32 s18, 0x4130
    s_cselect_b32 s19, 2048, 0
    s_or_b32 s13, s13, s19
    s_bfe_u32 s18, s10, 0xf0000
    s_cmp_le_u32 s18, 16431
    s_cselect_b32 s19, 4096, 0
    s_or_b32 s12, s12, s19
    s_cmp_le_u32 s18, 0x4130
    s_cselect_b32 s19, 4096, 0
    s_or_b32 s13, s13, s19
    s_bfe_u32 s18, s10, 0xf0010
    s_cmp_le_u32 s18, 16431
    s_cselect_b32 s19, 8192, 0
    s_or_b32 s12, s12, s19
    s_cmp_le_u32 s18, 0x4130
    s_cselect_b32 s19, 8192, 0
    s_or_b32 s13, s13, s19
    s_bfe_u32 s18, s11, 0xf0000
    s_cmp_le_u32 s18, 16431
    s_cselect_b32 s19, 16384, 0
    s_or_b32 s12, s12, s19
    s_cmp_le_u32 s18, 0x4130
    s_cselect_b32 s19, 16384, 0
    s_or_b32 s13, s13, s19
    s_bfe_u32 s18, s11, 0xf0010
    s_cmp_le_u32 s18, 16431
    s_cselect_b32 s19, 32768, 0
    s_or_b32 s12, s12, s19
    s_cmp_le_u32 s18, 0x4130
    s_cselect_b32 s19, 32768, 0
    s_or_b32 s13, s13, s19
    s_mov_b32 s8, s12
    s_andn2_b32 s9, s13, s12
    s_bcnt1_i32_b32 s10, s8
    s_bcnt1_i32_b32 s12, s9
    s_lshl_b32 s18, s12, 2
    s_mov_b32 s37, 0
    s_cmp_le_u32 s18, s10
    s_cselect_b32 s18, 1, 0
    s_cmp_lg_u32 s12, 0
    s_cselect_b32 s18, s18, 0
    s_add_u32 s37, s32, 1
    s_mul_i32 s37, s37, s18
    s_cmp_lg_u32 s51, 0
    s_cselect_b32 s37, 0, s37
    s_lshl_b32 s12, s12, 7
    s_lshl_b32 s10, s10, 4
    s_and_b32 s18, s14, 15
    s_lshl_b32 s18, 1, s18
    s_sub_u32 s18, s18, 1
    s_and_b32 s18, s18, s8
    s_bcnt1_i32_b32 s11, s18
    s_lshl_b32 s11, s11, 4
    s_lshr_b32 s18, s14, 4
    s_lshl_b32 s18, s18, 2
    s_add_u32 s11, s11, s18
    s_add_u32 s11, s11, s15
    s_mov_b32 s13, 0
    s_mov_b32 s36, 2
    s_waitcnt vmcnt(12)
    s_branch L_hunit
L_stubB:
    s_branch L_tret
L_vp2:
    s_cmp_eq_u32 s36, 2
    s_cbranch_scc0 L_vp5
    s_waitcnt lgkmcnt(0)
    v_mov_b32 v147, 1
    s_mov_b64 exec, 1
    ds_add_u32 v148, v147 offset:8
    s_mov_b64 exec, -1
    s_mov_b32 s38, 1
L_blk:
    s_lshl_b32 s47, s15, 2
    s_add_u32 s47, s47, s44
    s_add_u32 s47, s47, 16
    s_mul_i32 s19, s47, 3584
    s_mov_b32 m0, s43
    s_nop 0
    buffer_load_dwordx4 v142, s[20:23], s19 offen offset:0 lds
    buffer_load_dwordx4 v142, s[20:23], s19 offen offset:1024 lds
    buffer_load_dwordx4 v142, s[20:23], s19 offen offset:2048 lds
    s_mov_b32 exec_hi, 0
    buffer_load_dwordx4 v142, s[20:23], s19 offen offset:3072 lds
    s_mov_b32 exec_hi, -1
    s_add_u32 s45, s43, 3584
    s_mov_b32 m0, s45
    s_nop 0
    buffer_load_dwordx4 v142, s[24:27], s19 offen offset:0 lds
    buffer_load_dwordx4 v142, s[24:27], s19 offen offset:1024 lds
    buffer_load_dwordx4 v142, s[24:27], s19 offen offset:2048 lds
    s_mov_b32 exec_hi, 0
    buffer_load_dwordx4 v142, s[24:27], s19 offen offset:3072 lds
    s_mov_b32 exec_hi, -1
    v_add_u32 v143, s39, v141
    v_add_u32 v140, s39, v145
    s_add_u32 s18, s39, 16384
    v_add_u32 v156, s18, v150
    v_add_u32 v157, s18, v142
    s_mov_b32 s42, 1
    s_mov_b32 s36, 5
    s_waitcnt vmcnt(20)
    s_branch L_hunit
L_vp5:
    s_cmp_eq_u32 s36, 5
    s_cbranch_scc0 L_vp6
    s_add_u32 s19, s39, 4096
    v_add_u32 v143, s19, v141
    v_add_u32 v140, s19, v145
    s_add_u32 s18, s19, 16384
    v_add_u32 v156, s18, v150
    v_add_u32 v157, s18, v142
    s_mov_b32 s36, 6
    s_waitcnt vmcnt(12)
    s_branch L_hunit
L_vp6:
    s_cmp_eq_u32 s36, 6
    s_cbranch_scc0 L_g2done
    s_cmp_lg_u32 s38, 1
    s_cbranch_scc1 L_kdone
    s_cmp_lg_u32 s51, 0
    s_cbranch_scc1 L_kdone
    s_mov_b32 s19, s47
    s_lshr_b32 s47, s19, 2
    s_lshl_b32 s47, s47, 15
    s_and_b32 s18, s19, 3
    s_lshl_b32 s18, s18, 12
    s_add_u32 s47, s47, s18
    s_add_u32 s94, s47, 16384
    v_add_u32 v143, s43, v141
    s_add_u32 s18, s43, 3584
    v_add_u32 v156, s18, v150
    s_mov_b32 s42, 2
    s_mov_b32 s36, 4
    s_waitcnt vmcnt(4)
    s_branch L_hunit
L_g2done:
    s_waitcnt vmcnt(0) lgkmcnt(0)
    s_lshl_b32 s45, s32, 3
    s_add_u32 s45, s45, 3
    v_mov_b32 v147, 1
    s_mov_b64 exec, 1
    ds_add_rtn_u32 v149, v148, v147 offset:0
    s_waitcnt lgkmcnt(0)
    v_readfirstlane_b32 s18, v149
    v_mov_b32 v147, 1
    s_nop 2
    s_cmp_eq_u32 s18, s45
    s_cbranch_scc0 L_nf1
    v_add_u32 v149, s15, v146
    buffer_store_byte v147, v149, s[96:99], 0 offen sc1
L_nf1:
    s_mov_b64 exec, -1
    s_barrier
    s_mov_b32 s38, 2
    s_xor_b32 s39, s39, 65536
    s_mov_b32 s48, 0x01010101
    v_add_u32 v155, 4, v148
    s_mov_b32 s46, 0
    s_cmp_lg_u32 s16, 8
    s_cbranch_scc1 L_spin
    s_mov_b32 s45, 2
L_poll:
    buffer_load_dword v149, v146, s[96:99], 0 offen sc1
    s_waitcnt vmcnt(0)
    v_readfirstlane_b32 s18, v149
    s_nop 3
    s_mov_b32 s45, 1
    s_and_b32 s18, s18, s48
    s_cmp_eq_u32 s18, s48
    s_cbranch_scc1 L_polldone
    s_mov_b32 s45, 2
    s_add_u32 s46, s46, 1
    s_cmp_lt_u32 s46, 12
    s_cbranch_scc0 L_polldone
    s_sleep 4
    s_branch L_poll
L_polldone:
    v_mov_b32 v149, s45
    ds_write_b32 v155, v149
L_spin:
    ds_read_b32 v149, v155
    s_waitcnt lgkmcnt(0)
    v_readfirstlane_b32 s46, v149
    s_nop 3
    s_cmp_lg_u32 s46, 0
    s_cbranch_scc1 L_k
    s_sleep 2
    s_branch L_spin
L_stubC:
    s_branch L_tret
L_steady:
    s_xor_b32 s39, s39, 65536
    s_cmp_eq_u32 s51, 0
    s_cbranch_scc1 L_k0
    s_mov_b32 s46, 2
L_k0:
    s_cmp_eq_u32 s37, 2
    s_cbranch_scc0 L_k
    s_cmp_eq_u32 s38, 3
    s_cbranch_scc0 L_k
    s_cmp_eq_u32 s46, 1
    s_cbranch_scc0 L_k
    s_mov_b32 s37, 3
    s_cmp_lt_u32 s44, 2
    s_cbranch_scc1 L_k
    s_cmp_lg_u32 s16, 10
    s_cbranch_scc1 L_spin2
    s_mov_b32 s57, 0
L_poll2:
    buffer_load_dword v149, v146, s[96:99], 0 offen sc1
    s_waitcnt vmcnt(0)
    v_readfirstlane_b32 s18, v149
    s_lshl_b32 s19, s15, 3
    s_nop 2
    s_lshr_b32 s18, s18, s19
    s_and_b32 s18, s18, 0xff
    s_mov_b32 s45, 1
    s_cmp_eq_u32 s18, 33
    s_cbranch_scc1 L_poll2d
    s_mov_b32 s45, 2
    s_add_u32 s57, s57, 1
    s_cmp_lt_u32 s57, 5
    s_cbranch_scc0 L_poll2d
    s_sleep 8
    s_branch L_poll2
L_poll2d:
    v_mov_b32 v149, s45
    ds_write_b32 v148, v149 offset:12
L_spin2:
    ds_read_b32 v149, v148 offset:12
    s_waitcnt lgkmcnt(0)
    v_readfirstlane_b32 s57, v149
    s_nop 3
    s_cmp_lg_u32 s57, 0
    s_cbranch_scc1 L_dec2
    s_sleep 2
    s_branch L_spin2
L_dec2:
    s_cmp_eq_u32 s57, 1
    s_cbranch_scc0 L_k
    s_and_b32 s19, s44, 1
    s_lshl_b32 s39, s19, 14
    s_add_u32 s39, s39, 98304
    s_lshl_b32 s47, s15, 3
    s_lshl_b32 s19, s19, 1
    s_add_u32 s47, s47, s19
    s_lshl_b32 s47, s47, 13
    s_add_u32 m0, s39, 0
    s_add_u32 s18, s47, 262144
    buffer_load_dwordx4 v142, s[60:63], s18 offen offset:0 lds
    buffer_load_dwordx4 v142, s[60:63], s18 offen offset:1024 lds
    buffer_load_dwordx4 v142, s[60:63], s18 offen offset:2048 lds
    buffer_load_dwordx4 v142, s[60:63], s18 offen offset:3072 lds
    s_add_u32 m0, s39, 4096
    s_add_u32 s18, s47, 266240
    buffer_load_dwordx4 v142, s[60:63], s18 offen offset:0 lds
    buffer_load_dwordx4 v142, s[60:63], s18 offen offset:1024 lds
    buffer_load_dwordx4 v142, s[60:63], s18 offen offset:2048 lds
    buffer_load_dwordx4 v142, s[60:63], s18 offen offset:3072 lds
    s_add_u32 m0, s39, 8192
    s_add_u32 s18, s47, 270336
    buffer_load_dwordx4 v142, s[60:63], s18 offen offset:0 lds
    buffer_load_dwordx4 v142, s[60:63], s18 offen offset:1024 lds
    buffer_load_dwordx4 v142, s[60:63], s18 offen offset:2048 lds
    buffer_load_dwordx4 v142, s[60:63], s18 offen offset:3072 lds
    s_add_u32 m0, s39, 12288
    s_add_u32 s18, s47, 274432
    buffer_load_dwordx4 v142, s[60:63], s18 offen offset:0 lds
    buffer_load_dwordx4 v142, s[60:63], s18 offen offset:1024 lds
    buffer_load_dwordx4 v142, s[60:63], s18 offen offset:2048 lds
    buffer_load_dwordx4 v142, s[60:63], s18 offen offset:3072 lds
    s_branch L_kdone
L_k:
    s_and_b32 s45, s38, 3
    s_lshl_b32 s45, s45, 2
    s_add_u32 s45, s45, s44
    s_cmp_eq_u32 s46, 1
    s_cbranch_scc0 L_fb
    s_lshr_b32 s47, s45, 1
    s_lshl_b32 s47, s47, 15
    s_and_b32 s18, s45, 1
    s_lshl_b32 s18, s18, 13
    s_add_u32 s47, s47, s18
    s_add_u32 m0, s39, 0
    s_add_u32 s18, s47, 0
    buffer_load_dwordx4 v142, s[60:63], s18 offen offset:0 lds
    buffer_load_dwordx4 v142, s[60:63], s18 offen offset:1024 lds
    buffer_load_dwordx4 v142, s[60:63], s18 offen offset:2048 lds
    buffer_load_dwordx4 v142, s[60:63], s18 offen offset:3072 lds
    s_add_u32 m0, s39, 4096
    s_add_u32 s18, s47, 4096
    buffer_load_dwordx4 v142, s[60:63], s18 offen offset:0 lds
    buffer_load_dwordx4 v142, s[60:63], s18 offen offset:1024 lds
    buffer_load_dwordx4 v142, s[60:63], s18 offen offset:2048 lds
    buffer_load_dwordx4 v142, s[60:63], s18 offen offset:3072 lds
    s_add_u32 m0, s39, 16384
    s_add_u32 s18, s47, 16384
    buffer_load_dwordx4 v142, s[60:63], s18 offen offset:0 lds
    buffer_load_dwordx4 v142, s[60:63], s18 offen offset:1024 lds
    buffer_load_dwordx4 v142, s[60:63], s18 offen offset:2048 lds
    buffer_load_dwordx4 v142, s[60:63], s18 offen offset:3072 lds
    s_add_u32 m0, s39, 20480
    s_add_u32 s18, s47, 20480
    buffer_load_dwordx4 v142, s[60:63], s18 offen offset:0 lds
    buffer_load_dwordx4 v142, s[60:63], s18 offen offset:1024 lds
    buffer_load_dwordx4 v142, s[60:63], s18 offen offset:2048 lds
    buffer_load_dwordx4 v142, s[60:63], s18 offen offset:3072 lds
    s_cmp_eq_u32 s37, 1
    s_cbranch_scc1 L_item
L_kdone:
    s_waitcnt vmcnt(0) lgkmcnt(0)
    s_barrier
    s_add_u32 s38, s38, 1
    s_cmp_lt_u32 s38, s41
    s_cbranch_scc1 L_steady
    s_cmp_eq_u32 s37, 3
    s_cbranch_scc0 L_nobp
    ds_read_b32 v149, v148 offset:12
    s_waitcnt lgkmcnt(0)
    v_readfirstlane_b32 s18, v149
    s_nop 3
    s_cmp_eq_u32 s18, 1
    s_cbranch_scc0 L_nobp
    s_lshl_b32 s39, s44, 13
    s_add_u32 s39, s39, 32768
    s_lshl_b32 s47, s15, 3
    s_add_u32 s47, s47, s44
    s_add_u32 s47, s47, 4
    s_lshl_b32 s47, s47, 13
    s_add_u32 m0, s39, 0
    s_add_u32 s18, s47, 262144
    buffer_load_dwordx4 v142, s[60:63], s18 offen offset:0 lds
    buffer_load_dwordx4 v142, s[60:63], s18 offen offset:1024 lds
    buffer_load_dwordx4 v142, s[60:63], s18 offen offset:2048 lds
    buffer_load_dwordx4 v142, s[60:63], s18 offen offset:3072 lds
    s_add_u32 m0, s39, 4096
    s_add_u32 s18, s47, 266240
    buffer_load_dwordx4 v142, s[60:63], s18 offen offset:0 lds
    buffer_load_dwordx4 v142, s[60:63], s18 offen offset:1024 lds
    buffer_load_dwordx4 v142, s[60:63], s18 offen offset:2048 lds
    buffer_load_dwordx4 v142, s[60:63], s18 offen offset:3072 lds
    s_waitcnt vmcnt(0)
    v_mov_b32 v147, 1
    s_mov_b64 exec, 1
    ds_add_u32 v148, v147 offset:48
    s_mov_b64 exec, -1
L_nobp:
    s_cmp_eq_u32 s16, 9
    s_cbranch_scc1 L_epi1
    s_cmp_eq_u32 s16, 8
    s_cbranch_scc1 L_epi0
L_hend:
    s_cmp_lg_u32 s32, 0
    s_cbranch_scc1 L_fin
L_bend:
    s_waitcnt lgkmcnt(0)
    s_barrier
    ds_read_b32 v149, v137 offset:52
    s_waitcnt lgkmcnt(0)
    v_readfirstlane_b32 s18, v149
    s_nop 3
    s_cmp_eq_u32 s18, 0
    s_cbranch_scc1 L_fin
    s_mov_b32 s50, 1
    s_setprio 0
    s_branch L_top
L_bad:
    s_mov_b64 vcc, 0
    v_mov_b32 v149, 1
    ds_write_b32 v137, v149 offset:52
    s_branch L_bend
L_hunit:
    ds_read_b64 v[4:5], v143 offset:0
    ds_read_b64 v[6:7], v143 offset:8
    ds_read_b64 v[8:9], v143 offset:16
    ds_read_b64 v[10:11], v143 offset:24
    ds_read_b64 v[12:13], v143 offset:32
    ds_read_b64 v[14:15], v143 offset:40
    ds_read_b64 v[16:17], v143 offset:48
    s_waitcnt lgkmcnt(0)
L_unit:
    v_lshlrev_b32 v22, 16, v4
    v_and_b32 v23, s3, v4
    v_lshlrev_b32 v24, 16, v5
    v_and_b32 v25, s3, v5
    v_lshlrev_b32 v26, 16, v6
    v_and_b32 v27, s3, v6
    v_lshlrev_b32 v28, 16, v7
    v_and_b32 v29, s3, v7
    v_lshlrev_b32 v30, 16, v8
    v_and_b32 v31, s3, v8
    v_lshlrev_b32 v32, 16, v9
    v_and_b32 v33, s3, v9
    v_lshlrev_b32 v34, 16, v10
    v_and_b32 v35, s3, v10
    v_lshlrev_b32 v36, 16, v11
    v_and_b32 v37, s3, v11
    v_lshlrev_b32 v38, 16, v12
    v_and_b32 v39, s3, v12
    v_lshlrev_b32 v40, 16, v13
    v_and_b32 v41, s3, v13
    v_lshlrev_b32 v42, 16, v14
    v_and_b32 v43, s3, v14
    v_lshlrev_b32 v44, 16, v15
    v_and_b32 v45, s3, v15
    v_lshlrev_b32 v46, 16, v16
    v_and_b32 v47, s3, v16
    v_lshlrev_b32 v48, 16, v17
    v_and_b32 v49, s3, v17
L_ustub:
    s_cbranch_vccnz L_tret
    v_mul_f32 v18, v22, v22
    v_mul_f32 v19, v23, v23
    v_fmac_f32 v18, v24, v24
    v_fmac_f32 v19, v25, v25
    v_fmac_f32 v18, v26, v26
    v_fmac_f32 v19, v27, v27
    v_fmac_f32 v18, v28, v28
    v_fmac_f32 v19, v29, v29
    v_fmac_f32 v18, v30, v30
    v_fmac_f32 v19, v31, v31
    v_fmac_f32 v18, v32, v32
    v_fmac_f32 v19, v33, v33
    v_fmac_f32 v18, v34, v34
    v_fmac_f32 v19, v35, v35
    v_fmac_f32 v18, v36, v36
    v_fmac_f32 v19, v37, v37
    v_fmac_f32 v18, v38, v38
    v_fmac_f32 v19, v39, v39
    v_fmac_f32 v18, v40, v40
    v_fmac_f32 v19, v41, v41
    v_fmac_f32 v18, v42, v42
    v_fmac_f32 v19, v43, v43
    v_fmac_f32 v18, v44, v44
    v_fmac_f32 v19, v45, v45
    v_fmac_f32 v18, v46, v46
    v_fmac_f32 v19, v47, v47
    v_fmac_f32 v18, v48, v48
    v_fmac_f32 v19, v49, v49
    v_add_f32 v18, v18, v19
    v_sqrt_f32 v18, v18
    s_nop 0
    v_add_f32 v18, 0x358637bd, v18
    v_rcp_f32 v20, v18
    s_nop 0
    v_mul_f32 v20, v20, v135
    v_mul_f32 v22, v22, v20
    v_mul_f32 v23, v23, v20
    v_mul_f32 v24, v24, v20
    v_mul_f32 v25, v25, v20
    v_mul_f32 v26, v26, v20
    v_mul_f32 v27, v27, v20
    v_mul_f32 v28, v28, v20
    v_mul_f32 v29, v29, v20
    v_mul_f32 v30, v30, v20
    v_mul_f32 v31, v31, v20
    v_mul_f32 v32, v32, v20
    v_mul_f32 v33, v33, v20
    v_mul_f32 v34, v34, v20
    v_mul_f32 v35, v35, v20
    v_mul_f32 v36, v36, v20
    v_mul_f32 v37, v37, v20
    v_mul_f32 v38, v38, v20
    v_mul_f32 v39, v39, v20
    v_mul_f32 v40, v40, v20
    v_mul_f32 v41, v41, v20
    v_mul_f32 v42, v42, v20
    v_mul_f32 v43, v43, v20
    v_mul_f32 v44, v44, v20
    v_mul_f32 v45, v45, v20
    v_mul_f32 v46, v46, v20
    v_mul_f32 v47, v47, v20
    v_mul_f32 v48, v48, v20
    v_mul_f32 v49, v49, v20
    s_cmp_eq_u32 s32, 0
    s_cbranch_scc1 L_ubf
    v_cvt_pk_f16_f32 v84, v22, v23
    v_cvt_pk_f16_f32 v85, v24, v25
    v_cvt_pk_f16_f32 v86, v26, v27
    v_cvt_pk_f16_f32 v87, v28, v29
    v_cvt_pk_f16_f32 v88, v30, v31
    v_cvt_pk_f16_f32 v89, v32, v33
    v_cvt_pk_f16_f32 v90, v34, v35
    v_cvt_pk_f16_f32 v91, v36, v37
    v_cvt_pk_f16_f32 v92, v38, v39
    v_cvt_pk_f16_f32 v93, v40, v41
    v_cvt_pk_f16_f32 v94, v42, v43
    v_cvt_pk_f16_f32 v95, v44, v45
    v_cvt_pk_f16_f32 v96, v46, v47
    v_cvt_pk_f16_f32 v97, v48, v49
    s_branch L_ucv
L_ubf:
    v_cvt_pk_bf16_f32 v84, v22, v23
    v_cvt_pk_bf16_f32 v85, v24, v25
    v_cvt_pk_bf16_f32 v86, v26, v27
    v_cvt_pk_bf16_f32 v87, v28, v29
    v_cvt_pk_bf16_f32 v88, v30, v31
    v_cvt_pk_bf16_f32 v89, v32, v33
    v_cvt_pk_bf16_f32 v90, v34, v35
    v_cvt_pk_bf16_f32 v91, v36, v37
    v_cvt_pk_bf16_f32 v92, v38, v39
    v_cvt_pk_bf16_f32 v93, v40, v41
    v_cvt_pk_bf16_f32 v94, v42, v43
    v_cvt_pk_bf16_f32 v95, v44, v45
    v_cvt_pk_bf16_f32 v96, v46, v47
    v_cvt_pk_bf16_f32 v97, v48, v49
L_ucv:
    v_mov_b32 v98, v136
    v_mov_b32 v99, 0
    s_cmp_ge_u32 s16, 8
    s_cbranch_scc1 L_hpost
    s_cmp_eq_u32 s36, 0
    s_cbranch_scc1 L_dry
    v_permlane32_swap_b32 v84, v88
    v_permlane32_swap_b32 v92, v96
    v_permlane32_swap_b32 v85, v89
    v_permlane32_swap_b32 v93, v97
    v_permlane32_swap_b32 v86, v90
    v_permlane32_swap_b32 v94, v98
    v_permlane32_swap_b32 v87, v91
    v_permlane32_swap_b32 v95, v99
L_post2:
    v_mov_b32 v4, 0
    v_mov_b32 v5, 0
    v_mov_b32 v6, 0
    v_mov_b32 v7, 0
    s_cbranch_vccnz L_tret
    s_xor_b32 s18, s32, 1
    s_or_b32 s18, s18, s51
    s_cmp_lg_u32 s18, 0
    s_cbranch_scc1 L_noqpub
    buffer_store_dwordx4 v[84:87], v142, s[60:63], s47 offen offset:0 sc1
    buffer_store_dwordx4 v[88:91], v142, s[60:63], s47 offen offset:1024 sc1
    buffer_store_dwordx4 v[92:95], v142, s[60:63], s47 offen offset:2048 sc1
    buffer_store_dwordx4 v[96:99], v142, s[60:63], s47 offen offset:3072 sc1
L_noqpub:
    v_mov_b32 v76, 0
    v_mov_b32 v28, 0
    v_mov_b32 v77, 0
    v_mov_b32 v29, 0
    v_mov_b32 v78, 0
    v_mov_b32 v30, 0
    v_mov_b32 v79, 0
    v_mov_b32 v31, 0
    v_mov_b32 v80, 0
    v_mov_b32 v32, 0
    v_mov_b32 v81, 0
    v_mov_b32 v33, 0
    v_mov_b32 v82, 0
    v_mov_b32 v34, 0
    v_mov_b32 v83, 0
    v_mov_b32 v35, 0
    v_mov_b32 v66, 0
    v_mov_b32 v67, 0
    v_mfma_f32_32x32x16_bf16 v[100:115], v[4:7], v[4:7], 0
    v_mfma_f32_32x32x16_bf16 v[116:131], v[4:7], v[4:7], 0
    s_mov_b32 s33, 4
    s_mov_b32 s35, 0x10
    s_mov_b32 s48, 0x1c
    s_cmp_ge_u32 s16, 4
    s_cbranch_scc1 L_nob0
    s_barrier
L_nob0:
    s_cmp_eq_u32 s32, 1
    s_cbranch_scc1 L_fast
    s_cmp_eq_u32 s32, 2
    s_cbranch_scc1 L_slow
    ds_read_b128 v[4:7], v1 offset:0
    ds_read_b128 v[8:11], v1 offset:1024
    ds_read_b128 v[20:23], v1 offset:16384
    ds_read_b128 v[24:27], v1 offset:17408
    ds_read_b128 v[12:15], v1 offset:2048
    ds_read_b128 v[16:19], v1 offset:3072
    s_waitcnt lgkmcnt(4)
    v_mfma_f32_32x32x16_bf16 v[36:51], v[4:7], v[84:87], 4.0
    v_mfma_f32_32x32x16_bf16 v[36:51], v[8:11], v[92:95], v[36:51]
    s_nop 15
L_main_u:
    v_mfma_f32_32x32x16_f16 v[116:131], v[28:31], v[76:79], v[116:131]
L_cand0:
    s_setprio 2
    v_exp_f16_sdwa v68, v36 dst_sel:WORD_0 dst_unused:UNUSED_PAD src0_sel:WORD_0
    v_exp_f16_sdwa v69, v38 dst_sel:WORD_0 dst_unused:UNUSED_PAD src0_sel:WORD_0
    v_exp_f16_sdwa v68, v37 dst_sel:WORD_1 dst_unused:UNUSED_PRESERVE src0_sel:WORD_0
    v_exp_f16_sdwa v69, v39 dst_sel:WORD_1 dst_unused:UNUSED_PRESERVE src0_sel:WORD_0
    v_mfma_f32_32x32x16_bf16 v[52:67], v[4:7], v[88:91], 4.0
L_cand1:
    v_exp_f16_sdwa v70, v40 dst_sel:WORD_0 dst_unused:UNUSED_PAD src0_sel:WORD_0
    v_exp_f16_sdwa v71, v42 dst_sel:WORD_0 dst_unused:UNUSED_PAD src0_sel:WORD_0
    v_exp_f16_sdwa v70, v41 dst_sel:WORD_1 dst_unused:UNUSED_PRESERVE src0_sel:WORD_0
    v_exp_f16_sdwa v71, v43 dst_sel:WORD_1 dst_unused:UNUSED_PRESERVE src0_sel:WORD_0
    v_mfma_f32_32x32x16_bf16 v[52:67], v[8:11], v[96:99], v[52:67]
L_cand2:
    v_exp_f16_sdwa v72, v44 dst_sel:WORD_0 dst_unused:UNUSED_PAD src0_sel:WORD_0
    v_exp_f16_sdwa v73, v46 dst_sel:WORD_0 dst_unused:UNUSED_PAD src0_sel:WORD_0
    v_exp_f16_sdwa v72, v45 dst_sel:WORD_1 dst_unused:UNUSED_PRESERVE src0_sel:WORD_0
    v_exp_f16_sdwa v73, v47 dst_sel:WORD_1 dst_unused:UNUSED_PRESERVE src0_sel:WORD_0
    v_mfma_f32_32x32x16_f16 v[116:131], v[32:35], v[80:83], v[116:131]
L_cand3:
    s_waitcnt lgkmcnt(0)
    v_exp_f16_sdwa v74, v48 dst_sel:WORD_0 dst_unused:UNUSED_PAD src0_sel:WORD_0
    v_exp_f16_sdwa v75, v50 dst_sel:WORD_0 dst_unused:UNUSED_PAD src0_sel:WORD_0
    v_exp_f16_sdwa v74, v49 dst_sel:WORD_1 dst_unused:UNUSED_PRESERVE src0_sel:WORD_0
    v_exp_f16_sdwa v75, v51 dst_sel:WORD_1 dst_unused:UNUSED_PRESERVE src0_sel:WORD_0
    v_mfma_f32_32x32x16_f16 v[100:115], v[20:23], v[68:71], v[100:115]
L_cand4:
    ds_read_b128 v[28:31], v1 offset:18432
    v_exp_f16_sdwa v76, v52 dst_sel:WORD_0 dst_unused:UNUSED_PAD src0_sel:WORD_0
    v_exp_f16_sdwa v77, v54 dst_sel:WORD_0 dst_unused:UNUSED_PAD src0_sel:WORD_0
    v_exp_f16_sdwa v76, v53 dst_sel:WORD_1 dst_unused:UNUSED_PRESERVE src0_sel:WORD_0
    v_exp_f16_sdwa v77, v55 dst_sel:WORD_1 dst_unused:UNUSED_PRESERVE src0_sel:WORD_0
    v_mfma_f32_32x32x16_bf16 v[36:51], v[12:15], v[84:87], 4.0
L_cand5:
    ds_read_b128 v[32:35], v1 offset:19456
    v_exp_f16_sdwa v78, v56 dst_sel:WORD_0 dst_unused:UNUSED_PAD src0_sel:WORD_0
    v_exp_f16_sdwa v79, v58 dst_sel:WORD_0 dst_unused:UNUSED_PAD src0_sel:WORD_0
    v_exp_f16_sdwa v78, v57 dst_sel:WORD_1 dst_unused:UNUSED_PRESERVE src0_sel:WORD_0
    v_exp_f16_sdwa v79, v59 dst_sel:WORD_1 dst_unused:UNUSED_PRESERVE src0_sel:WORD_0
    v_mfma_f32_32x32x16_bf16 v[36:51], v[16:19], v[92:95], v[36:51]
L_cand6:
    ds_read_b128 v[4:7], v1 offset:4096
    v_exp_f16_sdwa v80, v60 dst_sel:WORD_0 dst_unused:UNUSED_PAD src0_sel:WORD_0
    v_exp_f16_sdwa v81, v62 dst_sel:WORD_0 dst_unused:UNUSED_PAD src0_sel:WORD_0
    v_exp_f16_sdwa v80, v61 dst_sel:WORD_1 dst_unused:UNUSED_PRESERVE src0_sel:WORD_0
    v_exp_f16_sdwa v81, v63 dst_sel:WORD_1 dst_unused:UNUSED_PRESERVE src0_sel:WORD_0
    v_mfma_f32_32x32x16_f16 v[100:115], v[24:27], v[72:75], v[100:115]
L_cand7:
    s_cbranch_vccnz L_tret
    ds_read_b128 v[8:11], v1 offset:5120
    v_exp_f16_sdwa v82, v64 dst_sel:WORD_0 dst_unused:UNUSED_PAD src0_sel:WORD_0
    v_exp_f16_sdwa v83, v66 dst_sel:WORD_0 dst_unused:UNUSED_PAD src0_sel:WORD_0
    v_exp_f16_sdwa v82, v65 dst_sel:WORD_1 dst_unused:UNUSED_PRESERVE src0_sel:WORD_0
    v_exp_f16_sdwa v83, v67 dst_sel:WORD_1 dst_unused:UNUSED_PRESERVE src0_sel:WORD_0
    v_mfma_f32_32x32x16_f16 v[116:131], v[20:23], v[76:79], v[116:131]
L_cand8:
    v_exp_f16_sdwa v68, v36 dst_sel:WORD_0 dst_unused:UNUSED_PAD src0_sel:WORD_0
    v_exp_f16_sdwa v69, v38 dst_sel:WORD_0 dst_unused:UNUSED_PAD src0_sel:WORD_0
    v_exp_f16_sdwa v68, v37 dst_sel:WORD_1 dst_unused:UNUSED_PRESERVE src0_sel:WORD_0
    v_exp_f16_sdwa v69, v39 dst_sel:WORD_1 dst_unused:UNUSED_PRESERVE src0_sel:WORD_0
    v_mfma_f32_32x32x16_bf16 v[52:67], v[12:15], v[88:91], 4.0
L_cand9:
    v_exp_f16_sdwa v70, v40 dst_sel:WORD_0 dst_unused:UNUSED_PAD src0_sel:WORD_0
    v_exp_f16_sdwa v71, v42 dst_sel:WORD_0 dst_unused:UNUSED_PAD src0_sel:WORD_0
    v_exp_f16_sdwa v70, v41 dst_sel:WORD_1 dst_unused:UNUSED_PRESERVE src0_sel:WORD_0
    v_exp_f16_sdwa v71, v43 dst_sel:WORD_1 dst_unused:UNUSED_PRESERVE src0_sel:WORD_0
    v_mfma_f32_32x32x16_bf16 v[52:67], v[16:19], v[96:99], v[52:67]
L_cand10:
    v_exp_f16_sdwa v72, v44 dst_sel:WORD_0 dst_unused:UNUSED_PAD src0_sel:WORD_0
    v_exp_f16_sdwa v73, v46 dst_sel:WORD_0 dst_unused:UNUSED_PAD src0_sel:WORD_0
    v_exp_f16_sdwa v72, v45 dst_sel:WORD_1 dst_unused:UNUSED_PRESERVE src0_sel:WORD_0
    v_exp_f16_sdwa v73, v47 dst_sel:WORD_1 dst_unused:UNUSED_PRESERVE src0_sel:WORD_0
    v_mfma_f32_32x32x16_f16 v[116:131], v[24:27], v[80:83], v[116:131]
L_cand11:
    s_waitcnt lgkmcnt(0)
    v_exp_f16_sdwa v74, v48 dst_sel:WORD_0 dst_unused:UNUSED_PAD src0_sel:WORD_0
    v_exp_f16_sdwa v75, v50 dst_sel:WORD_0 dst_unused:UNUSED_PAD src0_sel:WORD_0
    v_exp_f16_sdwa v74, v49 dst_sel:WORD_1 dst_unused:UNUSED_PRESERVE src0_sel:WORD_0
    v_exp_f16_sdwa v75, v51 dst_sel:WORD_1 dst_unused:UNUSED_PRESERVE src0_sel:WORD_0
    v_mfma_f32_32x32x16_f16 v[100:115], v[28:31], v[68:71], v[100:115]
L_cand12:
    ds_read_b128 v[20:23], v1 offset:20480
    v_exp_f16_sdwa v76, v52 dst_sel:WORD_0 dst_unused:UNUSED_PAD src0_sel:WORD_0
    v_exp_f16_sdwa v77, v54 dst_sel:WORD_0 dst_unused:UNUSED_PAD src0_sel:WORD_0
    v_exp_f16_sdwa v76, v53 dst_sel:WORD_1 dst_unused:UNUSED_PRESERVE src0_sel:WORD_0
    v_exp_f16_sdwa v77, v55 dst_sel:WORD_1 dst_unused:UNUSED_PRESERVE src0_sel:WORD_0
    v_mfma_f32_32x32x16_bf16 v[36:51], v[4:7], v[84:87], 4.0
L_cand13:
    ds_read_b128 v[24:27], v1 offset:21504
    v_exp_f16_sdwa v78, v56 dst_sel:WORD_0 dst_unused:UNUSED_PAD src0_sel:WORD_0
    v_exp_f16_sdwa v79, v58 dst_sel:WORD_0 dst_unused:UNUSED_PAD src0_sel:WORD_0
    v_exp_f16_sdwa v78, v57 dst_sel:WORD_1 dst_unused:UNUSED_PRESERVE src0_sel:WORD_0
    v_exp_f16_sdwa v79, v59 dst_sel:WORD_1 dst_unused:UNUSED_PRESERVE src0_sel:WORD_0
    v_mfma_f32_32x32x16_bf16 v[36:51], v[8:11], v[92:95], v[36:51]
L_cand14:
    ds_read_b128 v[12:15], v1 offset:6144
    v_exp_f16_sdwa v80, v60 dst_sel:WORD_0 dst_unused:UNUSED_PAD src0_sel:WORD_0
    v_exp_f16_sdwa v81, v62 dst_sel:WORD_0 dst_unused:UNUSED_PAD src0_sel:WORD_0
    v_exp_f16_sdwa v80, v61 dst_sel:WORD_1 dst_unused:UNUSED_PRESERVE src0_sel:WORD_0
    v_exp_f16_sdwa v81, v63 dst_sel:WORD_1 dst_unused:UNUSED_PRESERVE src0_sel:WORD_0
    v_mfma_f32_32x32x16_f16 v[100:115], v[32:35], v[72:75], v[100:115]
L_cand15:
    ds_read_b128 v[16:19], v1 offset:7168
    v_exp_f16_sdwa v82, v64 dst_sel:WORD_0 dst_unused:UNUSED_PAD src0_sel:WORD_0
    v_exp_f16_sdwa v83, v66 dst_sel:WORD_0 dst_unused:UNUSED_PAD src0_sel:WORD_0
    v_exp_f16_sdwa v82, v65 dst_sel:WORD_1 dst_unused:UNUSED_PRESERVE src0_sel:WORD_0
    v_exp_f16_sdwa v83, v67 dst_sel:WORD_1 dst_unused:UNUSED_PRESERVE src0_sel:WORD_0
    v_mfma_f32_32x32x16_f16 v[116:131], v[28:31], v[76:79], v[116:131]
L_cand16:
    v_exp_f16_sdwa v68, v36 dst_sel:WORD_0 dst_unused:UNUSED_PAD src0_sel:WORD_0
    v_exp_f16_sdwa v69, v38 dst_sel:WORD_0 dst_unused:UNUSED_PAD src0_sel:WORD_0
    v_exp_f16_sdwa v68, v37 dst_sel:WORD_1 dst_unused:UNUSED_PRESERVE src0_sel:WORD_0
    v_exp_f16_sdwa v69, v39 dst_sel:WORD_1 dst_unused:UNUSED_PRESERVE src0_sel:WORD_0
    v_mfma_f32_32x32x16_bf16 v[52:67], v[4:7], v[88:91], 4.0
L_cand17:
    v_exp_f16_sdwa v70, v40 dst_sel:WORD_0 dst_unused:UNUSED_PAD src0_sel:WORD_0
    v_exp_f16_sdwa v71, v42 dst_sel:WORD_0 dst_unused:UNUSED_PAD src0_sel:WORD_0
    v_exp_f16_sdwa v70, v41 dst_sel:WORD_1 dst_unused:UNUSED_PRESERVE src0_sel:WORD_0
    v_exp_f16_sdwa v71, v43 dst_sel:WORD_1 dst_unused:UNUSED_PRESERVE src0_sel:WORD_0
    v_mfma_f32_32x32x16_bf16 v[52:67], v[8:11], v[96:99], v[52:67]
L_cand18:
    v_exp_f16_sdwa v72, v44 dst_sel:WORD_0 dst_unused:UNUSED_PAD src0_sel:WORD_0
    v_exp_f16_sdwa v73, v46 dst_sel:WORD_0 dst_unused:UNUSED_PAD src0_sel:WORD_0
    v_exp_f16_sdwa v72, v45 dst_sel:WORD_1 dst_unused:UNUSED_PRESERVE src0_sel:WORD_0
    v_exp_f16_sdwa v73, v47 dst_sel:WORD_1 dst_unused:UNUSED_PRESERVE src0_sel:WORD_0
    v_mfma_f32_32x32x16_f16 v[116:131], v[32:35], v[80:83], v[116:131]
L_cand19:
    s_waitcnt lgkmcnt(0)
    v_exp_f16_sdwa v74, v48 dst_sel:WORD_0 dst_unused:UNUSED_PAD src0_sel:WORD_0
    v_exp_f16_sdwa v75, v50 dst_sel:WORD_0 dst_unused:UNUSED_PAD src0_sel:WORD_0
    v_exp_f16_sdwa v74, v49 dst_sel:WORD_1 dst_unused:UNUSED_PRESERVE src0_sel:WORD_0
    v_exp_f16_sdwa v75, v51 dst_sel:WORD_1 dst_unused:UNUSED_PRESERVE src0_sel:WORD_0
    v_mfma_f32_32x32x16_f16 v[100:115], v[20:23], v[68:71], v[100:115]
L_cand20:
    ds_read_b128 v[28:31], v1 offset:22528
    v_exp_f16_sdwa v76, v52 dst_sel:WORD_0 dst_unused:UNUSED_PAD src0_sel:WORD_0
    v_exp_f16_sdwa v77, v54 dst_sel:WORD_0 dst_unused:UNUSED_PAD src0_sel:WORD_0
    v_exp_f16_sdwa v76, v53 dst_sel:WORD_1 dst_unused:UNUSED_PRESERVE src0_sel:WORD_0
    v_exp_f16_sdwa v77, v55 dst_sel:WORD_1 dst_unused:UNUSED_PRESERVE src0_sel:WORD_0
    v_mfma_f32_32x32x16_bf16 v[36:51], v[12:15], v[84:87], 4.0
L_cand21:
    ds_read_b128 v[32:35], v1 offset:23552
    v_exp_f16_sdwa v78, v56 dst_sel:WORD_0 dst_unused:UNUSED_PAD src0_sel:WORD_0
    v_exp_f16_sdwa v79, v58 dst_sel:WORD_0 dst_unused:UNUSED_PAD src0_sel:WORD_0
    v_exp_f16_sdwa v78, v57 dst_sel:WORD_1 dst_unused:UNUSED_PRESERVE src0_sel:WORD_0
    v_exp_f16_sdwa v79, v59 dst_sel:WORD_1 dst_unused:UNUSED_PRESERVE src0_sel:WORD_0
    v_mfma_f32_32x32x16_bf16 v[36:51], v[16:19], v[92:95], v[36:51]
L_cand22:
    ds_read_b128 v[4:7], v1 offset:8192
    v_exp_f16_sdwa v80, v60 dst_sel:WORD_0 dst_unused:UNUSED_PAD src0_sel:WORD_0
    v_exp_f16_sdwa v81, v62 dst_sel:WORD_0 dst_unused:UNUSED_PAD src0_sel:WORD_0
    v_exp_f16_sdwa v80, v61 dst_sel:WORD_1 dst_unused:UNUSED_PRESERVE src0_sel:WORD_0
    v_exp_f16_sdwa v81, v63 dst_sel:WORD_1 dst_unused:UNUSED_PRESERVE src0_sel:WORD_0
    v_mfma_f32_32x32x16_f16 v[100:115], v[24:27], v[72:75], v[100:115]
L_cand23:
    ds_read_b128 v[8:11], v1 offset:9216
    v_exp_f16_sdwa v82, v64 dst_sel:WORD_0 dst_unused:UNUSED_PAD src0_sel:WORD_0
    v_exp_f16_sdwa v83, v66 dst_sel:WORD_0 dst_unused:UNUSED_PAD src0_sel:WORD_0
    v_exp_f16_sdwa v82, v65 dst_sel:WORD_1 dst_unused:UNUSED_PRESERVE src0_sel:WORD_0
    v_exp_f16_sdwa v83, v67 dst_sel:WORD_1 dst_unused:UNUSED_PRESERVE src0_sel:WORD_0
    v_mfma_f32_32x32x16_f16 v[116:131], v[20:23], v[76:79], v[116:131]
L_cand24:
    v_exp_f16_sdwa v68, v36 dst_sel:WORD_0 dst_unused:UNUSED_PAD src0_sel:WORD_0
    v_exp_f16_sdwa v69, v38 dst_sel:WORD_0 dst_unused:UNUSED_PAD src0_sel:WORD_0
    v_exp_f16_sdwa v68, v37 dst_sel:WORD_1 dst_unused:UNUSED_PRESERVE src0_sel:WORD_0
    v_exp_f16_sdwa v69, v39 dst_sel:WORD_1 dst_unused:UNUSED_PRESERVE src0_sel:WORD_0
    v_mfma_f32_32x32x16_bf16 v[52:67], v[12:15], v[88:91], 4.0
L_cand25:
    v_exp_f16_sdwa v70, v40 dst_sel:WORD_0 dst_unused:UNUSED_PAD src0_sel:WORD_0
    v_exp_f16_sdwa v71, v42 dst_sel:WORD_0 dst_unused:UNUSED_PAD src0_sel:WORD_0
    v_exp_f16_sdwa v70, v41 dst_sel:WORD_1 dst_unused:UNUSED_PRESERVE src0_sel:WORD_0
    v_exp_f16_sdwa v71, v43 dst_sel:WORD_1 dst_unused:UNUSED_PRESERVE src0_sel:WORD_0
    v_mfma_f32_32x32x16_bf16 v[52:67], v[16:19], v[96:99], v[52:67]
L_cand26:
    v_exp_f16_sdwa v72, v44 dst_sel:WORD_0 dst_unused:UNUSED_PAD src0_sel:WORD_0
    v_exp_f16_sdwa v73, v46 dst_sel:WORD_0 dst_unused:UNUSED_PAD src0_sel:WORD_0
    v_exp_f16_sdwa v72, v45 dst_sel:WORD_1 dst_unused:UNUSED_PRESERVE src0_sel:WORD_0
    v_exp_f16_sdwa v73, v47 dst_sel:WORD_1 dst_unused:UNUSED_PRESERVE src0_sel:WORD_0
    v_mfma_f32_32x32x16_f16 v[116:131], v[24:27], v[80:83], v[116:131]
L_cand27:
    s_waitcnt lgkmcnt(0)
    v_exp_f16_sdwa v74, v48 dst_sel:WORD_0 dst_unused:UNUSED_PAD src0_sel:WORD_0
    v_exp_f16_sdwa v75, v50 dst_sel:WORD_0 dst_unused:UNUSED_PAD src0_sel:WORD_0
    v_exp_f16_sdwa v74, v49 dst_sel:WORD_1 dst_unused:UNUSED_PRESERVE src0_sel:WORD_0
    v_exp_f16_sdwa v75, v51 dst_sel:WORD_1 dst_unused:UNUSED_PRESERVE src0_sel:WORD_0
    v_mfma_f32_32x32x16_f16 v[100:115], v[28:31], v[68:71], v[100:115]
L_cand28:
    ds_read_b128 v[20:23], v1 offset:24576
    v_exp_f16_sdwa v76, v52 dst_sel:WORD_0 dst_unused:UNUSED_PAD src0_sel:WORD_0
    v_exp_f16_sdwa v77, v54 dst_sel:WORD_0 dst_unused:UNUSED_PAD src0_sel:WORD_0
    v_exp_f16_sdwa v76, v53 dst_sel:WORD_1 dst_unused:UNUSED_PRESERVE src0_sel:WORD_0
    v_exp_f16_sdwa v77, v55 dst_sel:WORD_1 dst_unused:UNUSED_PRESERVE src0_sel:WORD_0
    v_mfma_f32_32x32x16_bf16 v[36:51], v[4:7], v[84:87], 4.0
L_cand29:
    ds_read_b128 v[24:27], v1 offset:25600
    v_exp_f16_sdwa v78, v56 dst_sel:WORD_0 dst_unused:UNUSED_PAD src0_sel:WORD_0
    v_exp_f16_sdwa v79, v58 dst_sel:WORD_0 dst_unused:UNUSED_PAD src0_sel:WORD_0
    v_exp_f16_sdwa v78, v57 dst_sel:WORD_1 dst_unused:UNUSED_PRESERVE src0_sel:WORD_0
    v_exp_f16_sdwa v79, v59 dst_sel:WORD_1 dst_unused:UNUSED_PRESERVE src0_sel:WORD_0
    v_mfma_f32_32x32x16_bf16 v[36:51], v[8:11], v[92:95], v[36:51]
L_cand30:
    s_cbranch_vccnz L_tret
    ds_read_b128 v[12:15], v1 offset:10240
    v_exp_f16_sdwa v80, v60 dst_sel:WORD_0 dst_unused:UNUSED_PAD src0_sel:WORD_0
    v_exp_f16_sdwa v81, v62 dst_sel:WORD_0 dst_unused:UNUSED_PAD src0_sel:WORD_0
    v_exp_f16_sdwa v80, v61 dst_sel:WORD_1 dst_unused:UNUSED_PRESERVE src0_sel:WORD_0
    v_exp_f16_sdwa v81, v63 dst_sel:WORD_1 dst_unused:UNUSED_PRESERVE src0_sel:WORD_0
    v_mfma_f32_32x32x16_f16 v[100:115], v[32:35], v[72:75], v[100:115]
L_cand31:
    ds_read_b128 v[16:19], v1 offset:11264
    v_exp_f16_sdwa v82, v64 dst_sel:WORD_0 dst_unused:UNUSED_PAD src0_sel:WORD_0
    v_exp_f16_sdwa v83, v66 dst_sel:WORD_0 dst_unused:UNUSED_PAD src0_sel:WORD_0
    v_exp_f16_sdwa v82, v65 dst_sel:WORD_1 dst_unused:UNUSED_PRESERVE src0_sel:WORD_0
    v_exp_f16_sdwa v83, v67 dst_sel:WORD_1 dst_unused:UNUSED_PRESERVE src0_sel:WORD_0
    v_mfma_f32_32x32x16_f16 v[116:131], v[28:31], v[76:79], v[116:131]
L_cand32:
    v_exp_f16_sdwa v68, v36 dst_sel:WORD_0 dst_unused:UNUSED_PAD src0_sel:WORD_0
    v_exp_f16_sdwa v69, v38 dst_sel:WORD_0 dst_unused:UNUSED_PAD src0_sel:WORD_0
    v_exp_f16_sdwa v68, v37 dst_sel:WORD_1 dst_unused:UNUSED_PRESERVE src0_sel:WORD_0
    v_exp_f16_sdwa v69, v39 dst_sel:WORD_1 dst_unused:UNUSED_PRESERVE src0_sel:WORD_0
    v_mfma_f32_32x32x16_bf16 v[52:67], v[4:7], v[88:91], 4.0
L_cand33:
    v_exp_f16_sdwa v70, v40 dst_sel:WORD_0 dst_unused:UNUSED_PAD src0_sel:WORD_0
    v_exp_f16_sdwa v71, v42 dst_sel:WORD_0 dst_unused:UNUSED_PAD src0_sel:WORD_0
    v_exp_f16_sdwa v70, v41 dst_sel:WORD_1 dst_unused:UNUSED_PRESERVE src0_sel:WORD_0
    v_exp_f16_sdwa v71, v43 dst_sel:WORD_1 dst_unused:UNUSED_PRESERVE src0_sel:WORD_0
    v_mfma_f32_32x32x16_bf16 v[52:67], v[8:11], v[96:99], v[52:67]
L_cand34:
    v_exp_f16_sdwa v72, v44 dst_sel:WORD_0 dst_unused:UNUSED_PAD src0_sel:WORD_0
    v_exp_f16_sdwa v73, v46 dst_sel:WORD_0 dst_unused:UNUSED_PAD src0_sel:WORD_0
    v_exp_f16_sdwa v72, v45 dst_sel:WORD_1 dst_unused:UNUSED_PRESERVE src0_sel:WORD_0
    v_exp_f16_sdwa v73, v47 dst_sel:WORD_1 dst_unused:UNUSED_PRESERVE src0_sel:WORD_0
    v_mfma_f32_32x32x16_f16 v[116:131], v[32:35], v[80:83], v[116:131]
L_cand35:
    s_waitcnt lgkmcnt(0)
    v_exp_f16_sdwa v74, v48 dst_sel:WORD_0 dst_unused:UNUSED_PAD src0_sel:WORD_0
    v_exp_f16_sdwa v75, v50 dst_sel:WORD_0 dst_unused:UNUSED_PAD src0_sel:WORD_0
    v_exp_f16_sdwa v74, v49 dst_sel:WORD_1 dst_unused:UNUSED_PRESERVE src0_sel:WORD_0
    v_exp_f16_sdwa v75, v51 dst_sel:WORD_1 dst_unused:UNUSED_PRESERVE src0_sel:WORD_0
    v_mfma_f32_32x32x16_f16 v[100:115], v[20:23], v[68:71], v[100:115]
L_cand36:
    ds_read_b128 v[28:31], v1 offset:26624
    v_exp_f16_sdwa v76, v52 dst_sel:WORD_0 dst_unused:UNUSED_PAD src0_sel:WORD_0
    v_exp_f16_sdwa v77, v54 dst_sel:WORD_0 dst_unused:UNUSED_PAD src0_sel:WORD_0
    v_exp_f16_sdwa v76, v53 dst_sel:WORD_1 dst_unused:UNUSED_PRESERVE src0_sel:WORD_0
    v_exp_f16_sdwa v77, v55 dst_sel:WORD_1 dst_unused:UNUSED_PRESERVE src0_sel:WORD_0
    v_mfma_f32_32x32x16_bf16 v[36:51], v[12:15], v[84:87], 4.0
L_cand37:
    ds_read_b128 v[32:35], v1 offset:27648
    v_exp_f16_sdwa v78, v56 dst_sel:WORD_0 dst_unused:UNUSED_PAD src0_sel:WORD_0
    v_exp_f16_sdwa v79, v58 dst_sel:WORD_0 dst_unused:UNUSED_PAD src0_sel:WORD_0
    v_exp_f16_sdwa v78, v57 dst_sel:WORD_1 dst_unused:UNUSED_PRESERVE src0_sel:WORD_0
    v_exp_f16_sdwa v79, v59 dst_sel:WORD_1 dst_unused:UNUSED_PRESERVE src0_sel:WORD_0
    v_mfma_f32_32x32x16_bf16 v[36:51], v[16:19], v[92:95], v[36:51]
L_cand38:
    ds_read_b128 v[4:7], v1 offset:12288
    v_exp_f16_sdwa v80, v60 dst_sel:WORD_0 dst_unused:UNUSED_PAD src0_sel:WORD_0
    v_exp_f16_sdwa v81, v62 dst_sel:WORD_0 dst_unused:UNUSED_PAD src0_sel:WORD_0
    v_exp_f16_sdwa v80, v61 dst_sel:WORD_1 dst_unused:UNUSED_PRESERVE src0_sel:WORD_0
    v_exp_f16_sdwa v81, v63 dst_sel:WORD_1 dst_unused:UNUSED_PRESERVE src0_sel:WORD_0
    v_mfma_f32_32x32x16_f16 v[100:115], v[24:27], v[72:75], v[100:115]
L_cand39:
    ds_read_b128 v[8:11], v1 offset:13312
    v_exp_f16_sdwa v82, v64 dst_sel:WORD_0 dst_unused:UNUSED_PAD src0_sel:WORD_0
    v_exp_f16_sdwa v83, v66 dst_sel:WORD_0 dst_unused:UNUSED_PAD src0_sel:WORD_0
    v_exp_f16_sdwa v82, v65 dst_sel:WORD_1 dst_unused:UNUSED_PRESERVE src0_sel:WORD_0
    v_exp_f16_sdwa v83, v67 dst_sel:WORD_1 dst_unused:UNUSED_PRESERVE src0_sel:WORD_0
    v_mfma_f32_32x32x16_f16 v[116:131], v[20:23], v[76:79], v[116:131]
L_cand40:
    v_exp_f16_sdwa v68, v36 dst_sel:WORD_0 dst_unused:UNUSED_PAD src0_sel:WORD_0
    v_exp_f16_sdwa v69, v38 dst_sel:WORD_0 dst_unused:UNUSED_PAD src0_sel:WORD_0
    v_exp_f16_sdwa v68, v37 dst_sel:WORD_1 dst_unused:UNUSED_PRESERVE src0_sel:WORD_0
    v_exp_f16_sdwa v69, v39 dst_sel:WORD_1 dst_unused:UNUSED_PRESERVE src0_sel:WORD_0
    v_mfma_f32_32x32x16_bf16 v[52:67], v[12:15], v[88:91], 4.0
L_cand41:
    v_exp_f16_sdwa v70, v40 dst_sel:WORD_0 dst_unused:UNUSED_PAD src0_sel:WORD_0
    v_exp_f16_sdwa v71, v42 dst_sel:WORD_0 dst_unused:UNUSED_PAD src0_sel:WORD_0
    v_exp_f16_sdwa v70, v41 dst_sel:WORD_1 dst_unused:UNUSED_PRESERVE src0_sel:WORD_0
    v_exp_f16_sdwa v71, v43 dst_sel:WORD_1 dst_unused:UNUSED_PRESERVE src0_sel:WORD_0
    v_mfma_f32_32x32x16_bf16 v[52:67], v[16:19], v[96:99], v[52:67]
L_cand42:
    v_exp_f16_sdwa v72, v44 dst_sel:WORD_0 dst_unused:UNUSED_PAD src0_sel:WORD_0
    v_exp_f16_sdwa v73, v46 dst_sel:WORD_0 dst_unused:UNUSED_PAD src0_sel:WORD_0
    v_exp_f16_sdwa v72, v45 dst_sel:WORD_1 dst_unused:UNUSED_PRESERVE src0_sel:WORD_0
    v_exp_f16_sdwa v73, v47 dst_sel:WORD_1 dst_unused:UNUSED_PRESERVE src0_sel:WORD_0
    v_mfma_f32_32x32x16_f16 v[116:131], v[24:27], v[80:83], v[116:131]
L_cand43:
    s_waitcnt lgkmcnt(0)
    v_exp_f16_sdwa v74, v48 dst_sel:WORD_0 dst_unused:UNUSED_PAD src0_sel:WORD_0
    v_exp_f16_sdwa v75, v50 dst_sel:WORD_0 dst_unused:UNUSED_PAD src0_sel:WORD_0
    v_exp_f16_sdwa v74, v49 dst_sel:WORD_1 dst_unused:UNUSED_PRESERVE src0_sel:WORD_0
    v_exp_f16_sdwa v75, v51 dst_sel:WORD_1 dst_unused:UNUSED_PRESERVE src0_sel:WORD_0
    v_mfma_f32_32x32x16_f16 v[100:115], v[28:31], v[68:71], v[100:115]
L_cand44:
    ds_read_b128 v[20:23], v1 offset:28672
    v_exp_f16_sdwa v76, v52 dst_sel:WORD_0 dst_unused:UNUSED_PAD src0_sel:WORD_0
    v_exp_f16_sdwa v77, v54 dst_sel:WORD_0 dst_unused:UNUSED_PAD src0_sel:WORD_0
    v_exp_f16_sdwa v76, v53 dst_sel:WORD_1 dst_unused:UNUSED_PRESERVE src0_sel:WORD_0
    v_exp_f16_sdwa v77, v55 dst_sel:WORD_1 dst_unused:UNUSED_PRESERVE src0_sel:WORD_0
    v_mfma_f32_32x32x16_bf16 v[36:51], v[4:7], v[84:87], 4.0
L_cand45:
    ds_read_b128 v[24:27], v1 offset:29696
    v_exp_f16_sdwa v78, v56 dst_sel:WORD_0 dst_unused:UNUSED_PAD src0_sel:WORD_0
    v_exp_f16_sdwa v79, v58 dst_sel:WORD_0 dst_unused:UNUSED_PAD src0_sel:WORD_0
    v_exp_f16_sdwa v78, v57 dst_sel:WORD_1 dst_unused:UNUSED_PRESERVE src0_sel:WORD_0
    v_exp_f16_sdwa v79, v59 dst_sel:WORD_1 dst_unused:UNUSED_PRESERVE src0_sel:WORD_0
    v_mfma_f32_32x32x16_bf16 v[36:51], v[8:11], v[92:95], v[36:51]
L_cand46:
    ds_read_b128 v[12:15], v1 offset:14336
    v_exp_f16_sdwa v80, v60 dst_sel:WORD_0 dst_unused:UNUSED_PAD src0_sel:WORD_0
    v_exp_f16_sdwa v81, v62 dst_sel:WORD_0 dst_unused:UNUSED_PAD src0_sel:WORD_0
    v_exp_f16_sdwa v80, v61 dst_sel:WORD_1 dst_unused:UNUSED_PRESERVE src0_sel:WORD_0
    v_exp_f16_sdwa v81, v63 dst_sel:WORD_1 dst_unused:UNUSED_PRESERVE src0_sel:WORD_0
    v_mfma_f32_32x32x16_f16 v[100:115], v[32:35], v[72:75], v[100:115]
L_cand47:
    ds_read_b128 v[16:19], v1 offset:15360
    v_exp_f16_sdwa v82, v64 dst_sel:WORD_0 dst_unused:UNUSED_PAD src0_sel:WORD_0
    v_exp_f16_sdwa v83, v66 dst_sel:WORD_0 dst_unused:UNUSED_PAD src0_sel:WORD_0
    v_exp_f16_sdwa v82, v65 dst_sel:WORD_1 dst_unused:UNUSED_PRESERVE src0_sel:WORD_0
    v_exp_f16_sdwa v83, v67 dst_sel:WORD_1 dst_unused:UNUSED_PRESERVE src0_sel:WORD_0
    v_mfma_f32_32x32x16_f16 v[116:131], v[28:31], v[76:79], v[116:131]
L_cand48:
    s_setprio 1
    v_exp_f16_sdwa v68, v36 dst_sel:WORD_0 dst_unused:UNUSED_PAD src0_sel:WORD_0
    v_exp_f16_sdwa v69, v38 dst_sel:WORD_0 dst_unused:UNUSED_PAD src0_sel:WORD_0
    v_exp_f16_sdwa v68, v37 dst_sel:WORD_1 dst_unused:UNUSED_PRESERVE src0_sel:WORD_0
    v_exp_f16_sdwa v69, v39 dst_sel:WORD_1 dst_unused:UNUSED_PRESERVE src0_sel:WORD_0
    v_mfma_f32_32x32x16_bf16 v[52:67], v[4:7], v[88:91], 4.0
L_cand49:
    v_exp_f16_sdwa v70, v40 dst_sel:WORD_0 dst_unused:UNUSED_PAD src0_sel:WORD_0
    v_exp_f16_sdwa v71, v42 dst_sel:WORD_0 dst_unused:UNUSED_PAD src0_sel:WORD_0
    v_exp_f16_sdwa v70, v41 dst_sel:WORD_1 dst_unused:UNUSED_PRESERVE src0_sel:WORD_0
    v_exp_f16_sdwa v71, v43 dst_sel:WORD_1 dst_unused:UNUSED_PRESERVE src0_sel:WORD_0
    v_mfma_f32_32x32x16_bf16 v[52:67], v[8:11], v[96:99], v[52:67]
L_cand50:
    v_exp_f16_sdwa v72, v44 dst_sel:WORD_0 dst_unused:UNUSED_PAD src0_sel:WORD_0
    v_exp_f16_sdwa v73, v46 dst_sel:WORD_0 dst_unused:UNUSED_PAD src0_sel:WORD_0
    v_exp_f16_sdwa v72, v45 dst_sel:WORD_1 dst_unused:UNUSED_PRESERVE src0_sel:WORD_0
    v_exp_f16_sdwa v73, v47 dst_sel:WORD_1 dst_unused:UNUSED_PRESERVE src0_sel:WORD_0
    v_mfma_f32_32x32x16_f16 v[116:131], v[32:35], v[80:83], v[116:131]
L_cand51:
    s_waitcnt lgkmcnt(0)
    v_exp_f16_sdwa v74, v48 dst_sel:WORD_0 dst_unused:UNUSED_PAD src0_sel:WORD_0
    v_exp_f16_sdwa v75, v50 dst_sel:WORD_0 dst_unused:UNUSED_PAD src0_sel:WORD_0
    v_exp_f16_sdwa v74, v49 dst_sel:WORD_1 dst_unused:UNUSED_PRESERVE src0_sel:WORD_0
    v_exp_f16_sdwa v75, v51 dst_sel:WORD_1 dst_unused:UNUSED_PRESERVE src0_sel:WORD_0
    v_mfma_f32_32x32x16_f16 v[100:115], v[20:23], v[68:71], v[100:115]
L_cand52:
    ds_read_b128 v[28:31], v1 offset:30720
    v_exp_f16_sdwa v76, v52 dst_sel:WORD_0 dst_unused:UNUSED_PAD src0_sel:WORD_0
    v_exp_f16_sdwa v77, v54 dst_sel:WORD_0 dst_unused:UNUSED_PAD src0_sel:WORD_0
    v_exp_f16_sdwa v76, v53 dst_sel:WORD_1 dst_unused:UNUSED_PRESERVE src0_sel:WORD_0
    v_exp_f16_sdwa v77, v55 dst_sel:WORD_1 dst_unused:UNUSED_PRESERVE src0_sel:WORD_0
    v_mfma_f32_32x32x16_bf16 v[36:51], v[12:15], v[84:87], 4.0
L_cand53:
    ds_read_b128 v[32:35], v1 offset:31744
    v_exp_f16_sdwa v78, v56 dst_sel:WORD_0 dst_unused:UNUSED_PAD src0_sel:WORD_0
    v_exp_f16_sdwa v79, v58 dst_sel:WORD_0 dst_unused:UNUSED_PAD src0_sel:WORD_0
    v_exp_f16_sdwa v78, v57 dst_sel:WORD_1 dst_unused:UNUSED_PRESERVE src0_sel:WORD_0
    v_exp_f16_sdwa v79, v59 dst_sel:WORD_1 dst_unused:UNUSED_PRESERVE src0_sel:WORD_0
    v_mfma_f32_32x32x16_bf16 v[36:51], v[16:19], v[92:95], v[36:51]
L_cand54:
    v_exp_f16_sdwa v80, v60 dst_sel:WORD_0 dst_unused:UNUSED_PAD src0_sel:WORD_0
    v_exp_f16_sdwa v81, v62 dst_sel:WORD_0 dst_unused:UNUSED_PAD src0_sel:WORD_0
    v_exp_f16_sdwa v80, v61 dst_sel:WORD_1 dst_unused:UNUSED_PRESERVE src0_sel:WORD_0
    v_exp_f16_sdwa v81, v63 dst_sel:WORD_1 dst_unused:UNUSED_PRESERVE src0_sel:WORD_0
    v_mfma_f32_32x32x16_f16 v[100:115], v[24:27], v[72:75], v[100:115]
L_cand55:
    v_exp_f16_sdwa v82, v64 dst_sel:WORD_0 dst_unused:UNUSED_PAD src0_sel:WORD_0
    v_exp_f16_sdwa v83, v66 dst_sel:WORD_0 dst_unused:UNUSED_PAD src0_sel:WORD_0
    v_exp_f16_sdwa v82, v65 dst_sel:WORD_1 dst_unused:UNUSED_PRESERVE src0_sel:WORD_0
    v_exp_f16_sdwa v83, v67 dst_sel:WORD_1 dst_unused:UNUSED_PRESERVE src0_sel:WORD_0
    v_mfma_f32_32x32x16_f16 v[116:131], v[20:23], v[76:79], v[116:131]
L_cand56:
    v_exp_f16_sdwa v68, v36 dst_sel:WORD_0 dst_unused:UNUSED_PAD src0_sel:WORD_0
    v_exp_f16_sdwa v69, v38 dst_sel:WORD_0 dst_unused:UNUSED_PAD src0_sel:WORD_0
    v_exp_f16_sdwa v68, v37 dst_sel:WORD_1 dst_unused:UNUSED_PRESERVE src0_sel:WORD_0
    v_exp_f16_sdwa v69, v39 dst_sel:WORD_1 dst_unused:UNUSED_PRESERVE src0_sel:WORD_0
    v_mfma_f32_32x32x16_bf16 v[52:67], v[12:15], v[88:91], 4.0
L_cand57:
    s_bitcmp1_b32 s35, s33
    v_exp_f16_sdwa v70, v40 dst_sel:WORD_0 dst_unused:UNUSED_PAD src0_sel:WORD_0
    v_exp_f16_sdwa v71, v42 dst_sel:WORD_0 dst_unused:UNUSED_PAD src0_sel:WORD_0
    v_exp_f16_sdwa v70, v41 dst_sel:WORD_1 dst_unused:UNUSED_PRESERVE src0_sel:WORD_0
    v_exp_f16_sdwa v71, v43 dst_sel:WORD_1 dst_unused:UNUSED_PRESERVE src0_sel:WORD_0
    v_mfma_f32_32x32x16_bf16 v[52:67], v[16:19], v[96:99], v[52:67]
L_cand58:
    v_exp_f16_sdwa v72, v44 dst_sel:WORD_0 dst_unused:UNUSED_PAD src0_sel:WORD_0
    v_exp_f16_sdwa v73, v46 dst_sel:WORD_0 dst_unused:UNUSED_PAD src0_sel:WORD_0
    v_exp_f16_sdwa v72, v45 dst_sel:WORD_1 dst_unused:UNUSED_PRESERVE src0_sel:WORD_0
    v_exp_f16_sdwa v73, v47 dst_sel:WORD_1 dst_unused:UNUSED_PRESERVE src0_sel:WORD_0
    v_mfma_f32_32x32x16_f16 v[116:131], v[24:27], v[80:83], v[116:131]
L_cand59:
    s_waitcnt lgkmcnt(0)
    s_cbranch_scc0 L_nobar_u7
    s_branch L_c1wait_u
L_nobar_u7:
    ds_read_b128 v[4:7], v1 offset:32768
    ds_read_b128 v[8:11], v1 offset:33792
    v_exp_f16_sdwa v74, v48 dst_sel:WORD_0 dst_unused:UNUSED_PAD src0_sel:WORD_0
    v_exp_f16_sdwa v75, v50 dst_sel:WORD_0 dst_unused:UNUSED_PAD src0_sel:WORD_0
    v_exp_f16_sdwa v74, v49 dst_sel:WORD_1 dst_unused:UNUSED_PRESERVE src0_sel:WORD_0
    v_exp_f16_sdwa v75, v51 dst_sel:WORD_1 dst_unused:UNUSED_PRESERVE src0_sel:WORD_0
    v_mfma_f32_32x32x16_f16 v[100:115], v[28:31], v[68:71], v[100:115]
L_cand60:
    ds_read_b128 v[20:23], v1 offset:49152
    v_exp_f16_sdwa v76, v52 dst_sel:WORD_0 dst_unused:UNUSED_PAD src0_sel:WORD_0
    v_exp_f16_sdwa v77, v54 dst_sel:WORD_0 dst_unused:UNUSED_PAD src0_sel:WORD_0
    v_exp_f16_sdwa v76, v53 dst_sel:WORD_1 dst_unused:UNUSED_PRESERVE src0_sel:WORD_0
    v_exp_f16_sdwa v77, v55 dst_sel:WORD_1 dst_unused:UNUSED_PRESERVE src0_sel:WORD_0
    s_waitcnt lgkmcnt(1)
    v_mfma_f32_32x32x16_bf16 v[36:51], v[4:7], v[84:87], 4.0
L_cand61:
    ds_read_b128 v[24:27], v1 offset:50176
    v_exp_f16_sdwa v78, v56 dst_sel:WORD_0 dst_unused:UNUSED_PAD src0_sel:WORD_0
    v_exp_f16_sdwa v79, v58 dst_sel:WORD_0 dst_unused:UNUSED_PAD src0_sel:WORD_0
    v_exp_f16_sdwa v78, v57 dst_sel:WORD_1 dst_unused:UNUSED_PRESERVE src0_sel:WORD_0
    v_exp_f16_sdwa v79, v59 dst_sel:WORD_1 dst_unused:UNUSED_PRESERVE src0_sel:WORD_0
    v_mfma_f32_32x32x16_bf16 v[36:51], v[8:11], v[92:95], v[36:51]
L_cand62:
    ds_read_b128 v[12:15], v1 offset:34816
    v_exp_f16_sdwa v80, v60 dst_sel:WORD_0 dst_unused:UNUSED_PAD src0_sel:WORD_0
    v_exp_f16_sdwa v81, v62 dst_sel:WORD_0 dst_unused:UNUSED_PAD src0_sel:WORD_0
    v_exp_f16_sdwa v80, v61 dst_sel:WORD_1 dst_unused:UNUSED_PRESERVE src0_sel:WORD_0
    v_exp_f16_sdwa v81, v63 dst_sel:WORD_1 dst_unused:UNUSED_PRESERVE src0_sel:WORD_0
    v_mfma_f32_32x32x16_f16 v[100:115], v[32:35], v[72:75], v[100:115]
L_cand63:
    ds_read_b128 v[16:19], v1 offset:35840
    v_exp_f16_sdwa v82, v64 dst_sel:WORD_0 dst_unused:UNUSED_PAD src0_sel:WORD_0
    v_exp_f16_sdwa v83, v66 dst_sel:WORD_0 dst_unused:UNUSED_PAD src0_sel:WORD_0
    v_exp_f16_sdwa v82, v65 dst_sel:WORD_1 dst_unused:UNUSED_PRESERVE src0_sel:WORD_0
    v_exp_f16_sdwa v83, v67 dst_sel:WORD_1 dst_unused:UNUSED_PRESERVE src0_sel:WORD_0
    v_mfma_f32_32x32x16_f16 v[116:131], v[28:31], v[76:79], v[116:131]
L_cand64:
    v_exp_f16_sdwa v68, v36 dst_sel:WORD_0 dst_unused:UNUSED_PAD src0_sel:WORD_0
    v_exp_f16_sdwa v69, v38 dst_sel:WORD_0 dst_unused:UNUSED_PAD src0_sel:WORD_0
    v_exp_f16_sdwa v68, v37 dst_sel:WORD_1 dst_unused:UNUSED_PRESERVE src0_sel:WORD_0
    v_exp_f16_sdwa v69, v39 dst_sel:WORD_1 dst_unused:UNUSED_PRESERVE src0_sel:WORD_0
    v_mfma_f32_32x32x16_bf16 v[52:67], v[4:7], v[88:91], 4.0
L_cand65:
    v_exp_f16_sdwa v70, v40 dst_sel:WORD_0 dst_unused:UNUSED_PAD src0_sel:WORD_0
    v_exp_f16_sdwa v71, v42 dst_sel:WORD_0 dst_unused:UNUSED_PAD src0_sel:WORD_0
    v_exp_f16_sdwa v70, v41 dst_sel:WORD_1 dst_unused:UNUSED_PRESERVE src0_sel:WORD_0
    v_exp_f16_sdwa v71, v43 dst_sel:WORD_1 dst_unused:UNUSED_PRESERVE src0_sel:WORD_0
    v_mfma_f32_32x32x16_bf16 v[52:67], v[8:11], v[96:99], v[52:67]
L_cand66:
    v_exp_f16_sdwa v72, v44 dst_sel:WORD_0 dst_unused:UNUSED_PAD src0_sel:WORD_0
    v_exp_f16_sdwa v73, v46 dst_sel:WORD_0 dst_unused:UNUSED_PAD src0_sel:WORD_0
    v_exp_f16_sdwa v72, v45 dst_sel:WORD_1 dst_unused:UNUSED_PRESERVE src0_sel:WORD_0
    v_exp_f16_sdwa v73, v47 dst_sel:WORD_1 dst_unused:UNUSED_PRESERVE src0_sel:WORD_0
    v_mfma_f32_32x32x16_f16 v[116:131], v[32:35], v[80:83], v[116:131]
L_cand67:
    s_waitcnt lgkmcnt(0)
    v_exp_f16_sdwa v74, v48 dst_sel:WORD_0 dst_unused:UNUSED_PAD src0_sel:WORD_0
    v_exp_f16_sdwa v75, v50 dst_sel:WORD_0 dst_unused:UNUSED_PAD src0_sel:WORD_0
    v_exp_f16_sdwa v74, v49 dst_sel:WORD_1 dst_unused:UNUSED_PRESERVE src0_sel:WORD_0
    v_exp_f16_sdwa v75, v51 dst_sel:WORD_1 dst_unused:UNUSED_PRESERVE src0_sel:WORD_0
    v_mfma_f32_32x32x16_f16 v[100:115], v[20:23], v[68:71], v[100:115]
L_cand68:
    ds_read_b128 v[28:31], v1 offset:51200
    v_exp_f16_sdwa v76, v52 dst_sel:WORD_0 dst_unused:UNUSED_PAD src0_sel:WORD_0
    v_exp_f16_sdwa v77, v54 dst_sel:WORD_0 dst_unused:UNUSED_PAD src0_sel:WORD_0
    v_exp_f16_sdwa v76, v53 dst_sel:WORD_1 dst_unused:UNUSED_PRESERVE src0_sel:WORD_0
    v_exp_f16_sdwa v77, v55 dst_sel:WORD_1 dst_unused:UNUSED_PRESERVE src0_sel:WORD_0
    v_mfma_f32_32x32x16_bf16 v[36:51], v[12:15], v[84:87], 4.0
L_cand69:
    ds_read_b128 v[32:35], v1 offset:52224
    v_exp_f16_sdwa v78, v56 dst_sel:WORD_0 dst_unused:UNUSED_PAD src0_sel:WORD_0
    v_exp_f16_sdwa v79, v58 dst_sel:WORD_0 dst_unused:UNUSED_PAD src0_sel:WORD_0
    v_exp_f16_sdwa v78, v57 dst_sel:WORD_1 dst_unused:UNUSED_PRESERVE src0_sel:WORD_0
    v_exp_f16_sdwa v79, v59 dst_sel:WORD_1 dst_unused:UNUSED_PRESERVE src0_sel:WORD_0
    v_mfma_f32_32x32x16_bf16 v[36:51], v[16:19], v[92:95], v[36:51]
L_cand70:
    ds_read_b128 v[4:7], v1 offset:36864
    v_exp_f16_sdwa v80, v60 dst_sel:WORD_0 dst_unused:UNUSED_PAD src0_sel:WORD_0
    v_exp_f16_sdwa v81, v62 dst_sel:WORD_0 dst_unused:UNUSED_PAD src0_sel:WORD_0
    v_exp_f16_sdwa v80, v61 dst_sel:WORD_1 dst_unused:UNUSED_PRESERVE src0_sel:WORD_0
    v_exp_f16_sdwa v81, v63 dst_sel:WORD_1 dst_unused:UNUSED_PRESERVE src0_sel:WORD_0
    v_mfma_f32_32x32x16_f16 v[100:115], v[24:27], v[72:75], v[100:115]
L_cand71:
    ds_read_b128 v[8:11], v1 offset:37888
    v_exp_f16_sdwa v82, v64 dst_sel:WORD_0 dst_unused:UNUSED_PAD src0_sel:WORD_0
    v_exp_f16_sdwa v83, v66 dst_sel:WORD_0 dst_unused:UNUSED_PAD src0_sel:WORD_0
    v_exp_f16_sdwa v82, v65 dst_sel:WORD_1 dst_unused:UNUSED_PRESERVE src0_sel:WORD_0
    v_exp_f16_sdwa v83, v67 dst_sel:WORD_1 dst_unused:UNUSED_PRESERVE src0_sel:WORD_0
    v_mfma_f32_32x32x16_f16 v[116:131], v[20:23], v[76:79], v[116:131]
L_cand72:
    v_exp_f16_sdwa v68, v36 dst_sel:WORD_0 dst_unused:UNUSED_PAD src0_sel:WORD_0
    v_exp_f16_sdwa v69, v38 dst_sel:WORD_0 dst_unused:UNUSED_PAD src0_sel:WORD_0
    v_exp_f16_sdwa v68, v37 dst_sel:WORD_1 dst_unused:UNUSED_PRESERVE src0_sel:WORD_0
    v_exp_f16_sdwa v69, v39 dst_sel:WORD_1 dst_unused:UNUSED_PRESERVE src0_sel:WORD_0
    v_mfma_f32_32x32x16_bf16 v[52:67], v[12:15], v[88:91], 4.0
L_cand73:
    v_exp_f16_sdwa v70, v40 dst_sel:WORD_0 dst_unused:UNUSED_PAD src0_sel:WORD_0
    v_exp_f16_sdwa v71, v42 dst_sel:WORD_0 dst_unused:UNUSED_PAD src0_sel:WORD_0
    v_exp_f16_sdwa v70, v41 dst_sel:WORD_1 dst_unused:UNUSED_PRESERVE src0_sel:WORD_0
    v_exp_f16_sdwa v71, v43 dst_sel:WORD_1 dst_unused:UNUSED_PRESERVE src0_sel:WORD_0
    v_mfma_f32_32x32x16_bf16 v[52:67], v[16:19], v[96:99], v[52:67]
L_cand74:
    v_exp_f16_sdwa v72, v44 dst_sel:WORD_0 dst_unused:UNUSED_PAD src0_sel:WORD_0
    v_exp_f16_sdwa v73, v46 dst_sel:WORD_0 dst_unused:UNUSED_PAD src0_sel:WORD_0
    v_exp_f16_sdwa v72, v45 dst_sel:WORD_1 dst_unused:UNUSED_PRESERVE src0_sel:WORD_0
    v_exp_f16_sdwa v73, v47 dst_sel:WORD_1 dst_unused:UNUSED_PRESERVE src0_sel:WORD_0
    v_mfma_f32_32x32x16_f16 v[116:131], v[24:27], v[80:83], v[116:131]
L_cand75:
    s_waitcnt lgkmcnt(0)
    v_exp_f16_sdwa v74, v48 dst_sel:WORD_0 dst_unused:UNUSED_PAD src0_sel:WORD_0
    v_exp_f16_sdwa v75, v50 dst_sel:WORD_0 dst_unused:UNUSED_PAD src0_sel:WORD_0
    v_exp_f16_sdwa v74, v49 dst_sel:WORD_1 dst_unused:UNUSED_PRESERVE src0_sel:WORD_0
    v_exp_f16_sdwa v75, v51 dst_sel:WORD_1 dst_unused:UNUSED_PRESERVE src0_sel:WORD_0
    v_mfma_f32_32x32x16_f16 v[100:115], v[28:31], v[68:71], v[100:115]
L_cand76:
    s_cbranch_vccnz L_tret
    ds_read_b128 v[20:23], v1 offset:53248
    v_exp_f16_sdwa v76, v52 dst_sel:WORD_0 dst_unused:UNUSED_PAD src0_sel:WORD_0
    v_exp_f16_sdwa v77, v54 dst_sel:WORD_0 dst_unused:UNUSED_PAD src0_sel:WORD_0
    v_exp_f16_sdwa v76, v53 dst_sel:WORD_1 dst_unused:UNUSED_PRESERVE src0_sel:WORD_0
    v_exp_f16_sdwa v77, v55 dst_sel:WORD_1 dst_unused:UNUSED_PRESERVE src0_sel:WORD_0
    v_mfma_f32_32x32x16_bf16 v[36:51], v[4:7], v[84:87], 4.0
L_cand77:
    ds_read_b128 v[24:27], v1 offset:54272
    v_exp_f16_sdwa v78, v56 dst_sel:WORD_0 dst_unused:UNUSED_PAD src0_sel:WORD_0
    v_exp_f16_sdwa v79, v58 dst_sel:WORD_0 dst_unused:UNUSED_PAD src0_sel:WORD_0
    v_exp_f16_sdwa v78, v57 dst_sel:WORD_1 dst_unused:UNUSED_PRESERVE src0_sel:WORD_0
    v_exp_f16_sdwa v79, v59 dst_sel:WORD_1 dst_unused:UNUSED_PRESERVE src0_sel:WORD_0
    v_mfma_f32_32x32x16_bf16 v[36:51], v[8:11], v[92:95], v[36:51]
L_cand78:
    ds_read_b128 v[12:15], v1 offset:38912
    v_exp_f16_sdwa v80, v60 dst_sel:WORD_0 dst_unused:UNUSED_PAD src0_sel:WORD_0
    v_exp_f16_sdwa v81, v62 dst_sel:WORD_0 dst_unused:UNUSED_PAD src0_sel:WORD_0
    v_exp_f16_sdwa v80, v61 dst_sel:WORD_1 dst_unused:UNUSED_PRESERVE src0_sel:WORD_0
    v_exp_f16_sdwa v81, v63 dst_sel:WORD_1 dst_unused:UNUSED_PRESERVE src0_sel:WORD_0
    v_mfma_f32_32x32x16_f16 v[100:115], v[32:35], v[72:75], v[100:115]
L_cand79:
    ds_read_b128 v[16:19], v1 offset:39936
    v_exp_f16_sdwa v82, v64 dst_sel:WORD_0 dst_unused:UNUSED_PAD src0_sel:WORD_0
    v_exp_f16_sdwa v83, v66 dst_sel:WORD_0 dst_unused:UNUSED_PAD src0_sel:WORD_0
    v_exp_f16_sdwa v82, v65 dst_sel:WORD_1 dst_unused:UNUSED_PRESERVE src0_sel:WORD_0
    v_exp_f16_sdwa v83, v67 dst_sel:WORD_1 dst_unused:UNUSED_PRESERVE src0_sel:WORD_0
    v_mfma_f32_32x32x16_f16 v[116:131], v[28:31], v[76:79], v[116:131]
L_cand80:
    v_exp_f16_sdwa v68, v36 dst_sel:WORD_0 dst_unused:UNUSED_PAD src0_sel:WORD_0
    v_exp_f16_sdwa v69, v38 dst_sel:WORD_0 dst_unused:UNUSED_PAD src0_sel:WORD_0
    v_exp_f16_sdwa v68, v37 dst_sel:WORD_1 dst_unused:UNUSED_PRESERVE src0_sel:WORD_0
    v_exp_f16_sdwa v69, v39 dst_sel:WORD_1 dst_unused:UNUSED_PRESERVE src0_sel:WORD_0
    v_mfma_f32_32x32x16_bf16 v[52:67], v[4:7], v[88:91], 4.0
L_cand81:
    v_exp_f16_sdwa v70, v40 dst_sel:WORD_0 dst_unused:UNUSED_PAD src0_sel:WORD_0
    v_exp_f16_sdwa v71, v42 dst_sel:WORD_0 dst_unused:UNUSED_PAD src0_sel:WORD_0
    v_exp_f16_sdwa v70, v41 dst_sel:WORD_1 dst_unused:UNUSED_PRESERVE src0_sel:WORD_0
    v_exp_f16_sdwa v71, v43 dst_sel:WORD_1 dst_unused:UNUSED_PRESERVE src0_sel:WORD_0
    v_mfma_f32_32x32x16_bf16 v[52:67], v[8:11], v[96:99], v[52:67]
L_cand82:
    v_exp_f16_sdwa v72, v44 dst_sel:WORD_0 dst_unused:UNUSED_PAD src0_sel:WORD_0
    v_exp_f16_sdwa v73, v46 dst_sel:WORD_0 dst_unused:UNUSED_PAD src0_sel:WORD_0
    v_exp_f16_sdwa v72, v45 dst_sel:WORD_1 dst_unused:UNUSED_PRESERVE src0_sel:WORD_0
    v_exp_f16_sdwa v73, v47 dst_sel:WORD_1 dst_unused:UNUSED_PRESERVE src0_sel:WORD_0
    v_mfma_f32_32x32x16_f16 v[116:131], v[32:35], v[80:83], v[116:131]
L_cand83:
    s_waitcnt lgkmcnt(0)
    v_exp_f16_sdwa v74, v48 dst_sel:WORD_0 dst_unused:UNUSED_PAD src0_sel:WORD_0
    v_exp_f16_sdwa v75, v50 dst_sel:WORD_0 dst_unused:UNUSED_PAD src0_sel:WORD_0
    v_exp_f16_sdwa v74, v49 dst_sel:WORD_1 dst_unused:UNUSED_PRESERVE src0_sel:WORD_0
    v_exp_f16_sdwa v75, v51 dst_sel:WORD_1 dst_unused:UNUSED_PRESERVE src0_sel:WORD_0
    v_mfma_f32_32x32x16_f16 v[100:115], v[20:23], v[68:71], v[100:115]
L_cand84:
    ds_read_b128 v[28:31], v1 offset:55296
    v_exp_f16_sdwa v76, v52 dst_sel:WORD_0 dst_unused:UNUSED_PAD src0_sel:WORD_0
    v_exp_f16_sdwa v77, v54 dst_sel:WORD_0 dst_unused:UNUSED_PAD src0_sel:WORD_0
    v_exp_f16_sdwa v76, v53 dst_sel:WORD_1 dst_unused:UNUSED_PRESERVE src0_sel:WORD_0
    v_exp_f16_sdwa v77, v55 dst_sel:WORD_1 dst_unused:UNUSED_PRESERVE src0_sel:WORD_0
    v_mfma_f32_32x32x16_bf16 v[36:51], v[12:15], v[84:87], 4.0
L_cand85:
    ds_read_b128 v[32:35], v1 offset:56320
    v_exp_f16_sdwa v78, v56 dst_sel:WORD_0 dst_unused:UNUSED_PAD src0_sel:WORD_0
    v_exp_f16_sdwa v79, v58 dst_sel:WORD_0 dst_unused:UNUSED_PAD src0_sel:WORD_0
    v_exp_f16_sdwa v78, v57 dst_sel:WORD_1 dst_unused:UNUSED_PRESERVE src0_sel:WORD_0
    v_exp_f16_sdwa v79, v59 dst_sel:WORD_1 dst_unused:UNUSED_PRESERVE src0_sel:WORD_0
    v_mfma_f32_32x32x16_bf16 v[36:51], v[16:19], v[92:95], v[36:51]
L_cand86:
    ds_read_b128 v[4:7], v1 offset:40960
    v_exp_f16_sdwa v80, v60 dst_sel:WORD_0 dst_unused:UNUSED_PAD src0_sel:WORD_0
    v_exp_f16_sdwa v81, v62 dst_sel:WORD_0 dst_unused:UNUSED_PAD src0_sel:WORD_0
    v_exp_f16_sdwa v80, v61 dst_sel:WORD_1 dst_unused:UNUSED_PRESERVE src0_sel:WORD_0
    v_exp_f16_sdwa v81, v63 dst_sel:WORD_1 dst_unused:UNUSED_PRESERVE src0_sel:WORD_0
    v_mfma_f32_32x32x16_f16 v[100:115], v[24:27], v[72:75], v[100:115]
L_cand87:
    ds_read_b128 v[8:11], v1 offset:41984
    v_exp_f16_sdwa v82, v64 dst_sel:WORD_0 dst_unused:UNUSED_PAD src0_sel:WORD_0
    v_exp_f16_sdwa v83, v66 dst_sel:WORD_0 dst_unused:UNUSED_PAD src0_sel:WORD_0
    v_exp_f16_sdwa v82, v65 dst_sel:WORD_1 dst_unused:UNUSED_PRESERVE src0_sel:WORD_0
    v_exp_f16_sdwa v83, v67 dst_sel:WORD_1 dst_unused:UNUSED_PRESERVE src0_sel:WORD_0
    v_mfma_f32_32x32x16_f16 v[116:131], v[20:23], v[76:79], v[116:131]
L_cand88:
    v_exp_f16_sdwa v68, v36 dst_sel:WORD_0 dst_unused:UNUSED_PAD src0_sel:WORD_0
    v_exp_f16_sdwa v69, v38 dst_sel:WORD_0 dst_unused:UNUSED_PAD src0_sel:WORD_0
    v_exp_f16_sdwa v68, v37 dst_sel:WORD_1 dst_unused:UNUSED_PRESERVE src0_sel:WORD_0
    v_exp_f16_sdwa v69, v39 dst_sel:WORD_1 dst_unused:UNUSED_PRESERVE src0_sel:WORD_0
    v_mfma_f32_32x32x16_bf16 v[52:67], v[12:15], v[88:91], 4.0
L_cand89:
    v_exp_f16_sdwa v70, v40 dst_sel:WORD_0 dst_unused:UNUSED_PAD src0_sel:WORD_0
    v_exp_f16_sdwa v71, v42 dst_sel:WORD_0 dst_unused:UNUSED_PAD src0_sel:WORD_0
    v_exp_f16_sdwa v70, v41 dst_sel:WORD_1 dst_unused:UNUSED_PRESERVE src0_sel:WORD_0
    v_exp_f16_sdwa v71, v43 dst_sel:WORD_1 dst_unused:UNUSED_PRESERVE src0_sel:WORD_0
    v_mfma_f32_32x32x16_bf16 v[52:67], v[16:19], v[96:99], v[52:67]
L_cand90:
    v_exp_f16_sdwa v72, v44 dst_sel:WORD_0 dst_unused:UNUSED_PAD src0_sel:WORD_0
    v_exp_f16_sdwa v73, v46 dst_sel:WORD_0 dst_unused:UNUSED_PAD src0_sel:WORD_0
    v_exp_f16_sdwa v72, v45 dst_sel:WORD_1 dst_unused:UNUSED_PRESERVE src0_sel:WORD_0
    v_exp_f16_sdwa v73, v47 dst_sel:WORD_1 dst_unused:UNUSED_PRESERVE src0_sel:WORD_0
    v_mfma_f32_32x32x16_f16 v[116:131], v[24:27], v[80:83], v[116:131]
L_cand91:
    s_waitcnt lgkmcnt(0)
    v_exp_f16_sdwa v74, v48 dst_sel:WORD_0 dst_unused:UNUSED_PAD src0_sel:WORD_0
    v_exp_f16_sdwa v75, v50 dst_sel:WORD_0 dst_unused:UNUSED_PAD src0_sel:WORD_0
    v_exp_f16_sdwa v74, v49 dst_sel:WORD_1 dst_unused:UNUSED_PRESERVE src0_sel:WORD_0
    v_exp_f16_sdwa v75, v51 dst_sel:WORD_1 dst_unused:UNUSED_PRESERVE src0_sel:WORD_0
    v_mfma_f32_32x32x16_f16 v[100:115], v[28:31], v[68:71], v[100:115]
L_cand92:
    ds_read_b128 v[20:23], v1 offset:57344
    v_exp_f16_sdwa v76, v52 dst_sel:WORD_0 dst_unused:UNUSED_PAD src0_sel:WORD_0
    v_exp_f16_sdwa v77, v54 dst_sel:WORD_0 dst_unused:UNUSED_PAD src0_sel:WORD_0
    v_exp_f16_sdwa v76, v53 dst_sel:WORD_1 dst_unused:UNUSED_PRESERVE src0_sel:WORD_0
    v_exp_f16_sdwa v77, v55 dst_sel:WORD_1 dst_unused:UNUSED_PRESERVE src0_sel:WORD_0
    v_mfma_f32_32x32x16_bf16 v[36:51], v[4:7], v[84:87], 4.0
L_cand93:
    ds_read_b128 v[24:27], v1 offset:58368
    v_exp_f16_sdwa v78, v56 dst_sel:WORD_0 dst_unused:UNUSED_PAD src0_sel:WORD_0
    v_exp_f16_sdwa v79, v58 dst_sel:WORD_0 dst_unused:UNUSED_PAD src0_sel:WORD_0
    v_exp_f16_sdwa v78, v57 dst_sel:WORD_1 dst_unused:UNUSED_PRESERVE src0_sel:WORD_0
    v_exp_f16_sdwa v79, v59 dst_sel:WORD_1 dst_unused:UNUSED_PRESERVE src0_sel:WORD_0
    v_mfma_f32_32x32x16_bf16 v[36:51], v[8:11], v[92:95], v[36:51]
L_cand94:
    ds_read_b128 v[12:15], v1 offset:43008
    v_exp_f16_sdwa v80, v60 dst_sel:WORD_0 dst_unused:UNUSED_PAD src0_sel:WORD_0
    v_exp_f16_sdwa v81, v62 dst_sel:WORD_0 dst_unused:UNUSED_PAD src0_sel:WORD_0
    v_exp_f16_sdwa v80, v61 dst_sel:WORD_1 dst_unused:UNUSED_PRESERVE src0_sel:WORD_0
    v_exp_f16_sdwa v81, v63 dst_sel:WORD_1 dst_unused:UNUSED_PRESERVE src0_sel:WORD_0
    v_mfma_f32_32x32x16_f16 v[100:115], v[32:35], v[72:75], v[100:115]
L_cand95:
    ds_read_b128 v[16:19], v1 offset:44032
    v_exp_f16_sdwa v82, v64 dst_sel:WORD_0 dst_unused:UNUSED_PAD src0_sel:WORD_0
    v_exp_f16_sdwa v83, v66 dst_sel:WORD_0 dst_unused:UNUSED_PAD src0_sel:WORD_0
    v_exp_f16_sdwa v82, v65 dst_sel:WORD_1 dst_unused:UNUSED_PRESERVE src0_sel:WORD_0
    v_exp_f16_sdwa v83, v67 dst_sel:WORD_1 dst_unused:UNUSED_PRESERVE src0_sel:WORD_0
    v_mfma_f32_32x32x16_f16 v[116:131], v[28:31], v[76:79], v[116:131]
L_cand96:
    s_setprio 0
    v_exp_f16_sdwa v68, v36 dst_sel:WORD_0 dst_unused:UNUSED_PAD src0_sel:WORD_0
    v_exp_f16_sdwa v69, v38 dst_sel:WORD_0 dst_unused:UNUSED_PAD src0_sel:WORD_0
    v_exp_f16_sdwa v68, v37 dst_sel:WORD_1 dst_unused:UNUSED_PRESERVE src0_sel:WORD_0
    v_exp_f16_sdwa v69, v39 dst_sel:WORD_1 dst_unused:UNUSED_PRESERVE src0_sel:WORD_0
    v_mfma_f32_32x32x16_bf16 v[52:67], v[4:7], v[88:91], 4.0
L_cand97:
    v_exp_f16_sdwa v70, v40 dst_sel:WORD_0 dst_unused:UNUSED_PAD src0_sel:WORD_0
    v_exp_f16_sdwa v71, v42 dst_sel:WORD_0 dst_unused:UNUSED_PAD src0_sel:WORD_0
    v_exp_f16_sdwa v70, v41 dst_sel:WORD_1 dst_unused:UNUSED_PRESERVE src0_sel:WORD_0
    v_exp_f16_sdwa v71, v43 dst_sel:WORD_1 dst_unused:UNUSED_PRESERVE src0_sel:WORD_0
    v_mfma_f32_32x32x16_bf16 v[52:67], v[8:11], v[96:99], v[52:67]
L_cand98:
    v_exp_f16_sdwa v72, v44 dst_sel:WORD_0 dst_unused:UNUSED_PAD src0_sel:WORD_0
    v_exp_f16_sdwa v73, v46 dst_sel:WORD_0 dst_unused:UNUSED_PAD src0_sel:WORD_0
    v_exp_f16_sdwa v72, v45 dst_sel:WORD_1 dst_unused:UNUSED_PRESERVE src0_sel:WORD_0
    v_exp_f16_sdwa v73, v47 dst_sel:WORD_1 dst_unused:UNUSED_PRESERVE src0_sel:WORD_0
    v_mfma_f32_32x32x16_f16 v[116:131], v[32:35], v[80:83], v[116:131]
L_cand99:
    s_waitcnt lgkmcnt(0)
    v_exp_f16_sdwa v74, v48 dst_sel:WORD_0 dst_unused:UNUSED_PAD src0_sel:WORD_0
    v_exp_f16_sdwa v75, v50 dst_sel:WORD_0 dst_unused:UNUSED_PAD src0_sel:WORD_0
    v_exp_f16_sdwa v74, v49 dst_sel:WORD_1 dst_unused:UNUSED_PRESERVE src0_sel:WORD_0
    v_exp_f16_sdwa v75, v51 dst_sel:WORD_1 dst_unused:UNUSED_PRESERVE src0_sel:WORD_0
    v_mfma_f32_32x32x16_f16 v[100:115], v[20:23], v[68:71], v[100:115]
L_cand100:
    ds_read_b128 v[28:31], v1 offset:59392
    v_exp_f16_sdwa v76, v52 dst_sel:WORD_0 dst_unused:UNUSED_PAD src0_sel:WORD_0
    v_exp_f16_sdwa v77, v54 dst_sel:WORD_0 dst_unused:UNUSED_PAD src0_sel:WORD_0
    v_exp_f16_sdwa v76, v53 dst_sel:WORD_1 dst_unused:UNUSED_PRESERVE src0_sel:WORD_0
    v_exp_f16_sdwa v77, v55 dst_sel:WORD_1 dst_unused:UNUSED_PRESERVE src0_sel:WORD_0
    v_mfma_f32_32x32x16_bf16 v[36:51], v[12:15], v[84:87], 4.0
L_cand101:
    ds_read_b128 v[32:35], v1 offset:60416
    v_exp_f16_sdwa v78, v56 dst_sel:WORD_0 dst_unused:UNUSED_PAD src0_sel:WORD_0
    v_exp_f16_sdwa v79, v58 dst_sel:WORD_0 dst_unused:UNUSED_PAD src0_sel:WORD_0
    v_exp_f16_sdwa v78, v57 dst_sel:WORD_1 dst_unused:UNUSED_PRESERVE src0_sel:WORD_0
    v_exp_f16_sdwa v79, v59 dst_sel:WORD_1 dst_unused:UNUSED_PRESERVE src0_sel:WORD_0
    v_mfma_f32_32x32x16_bf16 v[36:51], v[16:19], v[92:95], v[36:51]
L_cand102:
    ds_read_b128 v[4:7], v1 offset:45056
    v_exp_f16_sdwa v80, v60 dst_sel:WORD_0 dst_unused:UNUSED_PAD src0_sel:WORD_0
    v_exp_f16_sdwa v81, v62 dst_sel:WORD_0 dst_unused:UNUSED_PAD src0_sel:WORD_0
    v_exp_f16_sdwa v80, v61 dst_sel:WORD_1 dst_unused:UNUSED_PRESERVE src0_sel:WORD_0
    v_exp_f16_sdwa v81, v63 dst_sel:WORD_1 dst_unused:UNUSED_PRESERVE src0_sel:WORD_0
    v_mfma_f32_32x32x16_f16 v[100:115], v[24:27], v[72:75], v[100:115]
L_cand103:
    ds_read_b128 v[8:11], v1 offset:46080
    v_exp_f16_sdwa v82, v64 dst_sel:WORD_0 dst_unused:UNUSED_PAD src0_sel:WORD_0
    v_exp_f16_sdwa v83, v66 dst_sel:WORD_0 dst_unused:UNUSED_PAD src0_sel:WORD_0
    v_exp_f16_sdwa v82, v65 dst_sel:WORD_1 dst_unused:UNUSED_PRESERVE src0_sel:WORD_0
    v_exp_f16_sdwa v83, v67 dst_sel:WORD_1 dst_unused:UNUSED_PRESERVE src0_sel:WORD_0
    v_mfma_f32_32x32x16_f16 v[116:131], v[20:23], v[76:79], v[116:131]
L_cand104:
    v_exp_f16_sdwa v68, v36 dst_sel:WORD_0 dst_unused:UNUSED_PAD src0_sel:WORD_0
    v_exp_f16_sdwa v69, v38 dst_sel:WORD_0 dst_unused:UNUSED_PAD src0_sel:WORD_0
    v_exp_f16_sdwa v68, v37 dst_sel:WORD_1 dst_unused:UNUSED_PRESERVE src0_sel:WORD_0
    v_exp_f16_sdwa v69, v39 dst_sel:WORD_1 dst_unused:UNUSED_PRESERVE src0_sel:WORD_0
    v_mfma_f32_32x32x16_bf16 v[52:67], v[12:15], v[88:91], 4.0
L_cand105:
    v_exp_f16_sdwa v70, v40 dst_sel:WORD_0 dst_unused:UNUSED_PAD src0_sel:WORD_0
    v_exp_f16_sdwa v71, v42 dst_sel:WORD_0 dst_unused:UNUSED_PAD src0_sel:WORD_0
    v_exp_f16_sdwa v70, v41 dst_sel:WORD_1 dst_unused:UNUSED_PRESERVE src0_sel:WORD_0
    v_exp_f16_sdwa v71, v43 dst_sel:WORD_1 dst_unused:UNUSED_PRESERVE src0_sel:WORD_0
    v_mfma_f32_32x32x16_bf16 v[52:67], v[16:19], v[96:99], v[52:67]
L_cand106:
    v_exp_f16_sdwa v72, v44 dst_sel:WORD_0 dst_unused:UNUSED_PAD src0_sel:WORD_0
    v_exp_f16_sdwa v73, v46 dst_sel:WORD_0 dst_unused:UNUSED_PAD src0_sel:WORD_0
    v_exp_f16_sdwa v72, v45 dst_sel:WORD_1 dst_unused:UNUSED_PRESERVE src0_sel:WORD_0
    v_exp_f16_sdwa v73, v47 dst_sel:WORD_1 dst_unused:UNUSED_PRESERVE src0_sel:WORD_0
    v_mfma_f32_32x32x16_f16 v[116:131], v[24:27], v[80:83], v[116:131]
L_cand107:
    s_waitcnt lgkmcnt(0)
    v_exp_f16_sdwa v74, v48 dst_sel:WORD_0 dst_unused:UNUSED_PAD src0_sel:WORD_0
    v_exp_f16_sdwa v75, v50 dst_sel:WORD_0 dst_unused:UNUSED_PAD src0_sel:WORD_0
    v_exp_f16_sdwa v74, v49 dst_sel:WORD_1 dst_unused:UNUSED_PRESERVE src0_sel:WORD_0
    v_exp_f16_sdwa v75, v51 dst_sel:WORD_1 dst_unused:UNUSED_PRESERVE src0_sel:WORD_0
    v_mfma_f32_32x32x16_f16 v[100:115], v[28:31], v[68:71], v[100:115]
L_cand108:
    ds_read_b128 v[20:23], v1 offset:61440
    v_exp_f16_sdwa v76, v52 dst_sel:WORD_0 dst_unused:UNUSED_PAD src0_sel:WORD_0
    v_exp_f16_sdwa v77, v54 dst_sel:WORD_0 dst_unused:UNUSED_PAD src0_sel:WORD_0
    v_exp_f16_sdwa v76, v53 dst_sel:WORD_1 dst_unused:UNUSED_PRESERVE src0_sel:WORD_0
    v_exp_f16_sdwa v77, v55 dst_sel:WORD_1 dst_unused:UNUSED_PRESERVE src0_sel:WORD_0
    v_mfma_f32_32x32x16_bf16 v[36:51], v[4:7], v[84:87], 4.0
L_cand109:
    ds_read_b128 v[24:27], v1 offset:62464
    v_exp_f16_sdwa v78, v56 dst_sel:WORD_0 dst_unused:UNUSED_PAD src0_sel:WORD_0
    v_exp_f16_sdwa v79, v58 dst_sel:WORD_0 dst_unused:UNUSED_PAD src0_sel:WORD_0
    v_exp_f16_sdwa v78, v57 dst_sel:WORD_1 dst_unused:UNUSED_PRESERVE src0_sel:WORD_0
    v_exp_f16_sdwa v79, v59 dst_sel:WORD_1 dst_unused:UNUSED_PRESERVE src0_sel:WORD_0
    v_mfma_f32_32x32x16_bf16 v[36:51], v[8:11], v[92:95], v[36:51]
L_cand110:
    ds_read_b128 v[12:15], v1 offset:47104
    v_exp_f16_sdwa v80, v60 dst_sel:WORD_0 dst_unused:UNUSED_PAD src0_sel:WORD_0
    v_exp_f16_sdwa v81, v62 dst_sel:WORD_0 dst_unused:UNUSED_PAD src0_sel:WORD_0
    v_exp_f16_sdwa v80, v61 dst_sel:WORD_1 dst_unused:UNUSED_PRESERVE src0_sel:WORD_0
    v_exp_f16_sdwa v81, v63 dst_sel:WORD_1 dst_unused:UNUSED_PRESERVE src0_sel:WORD_0
    v_mfma_f32_32x32x16_f16 v[100:115], v[32:35], v[72:75], v[100:115]
L_cand111:
    ds_read_b128 v[16:19], v1 offset:48128
    v_exp_f16_sdwa v82, v64 dst_sel:WORD_0 dst_unused:UNUSED_PAD src0_sel:WORD_0
    v_exp_f16_sdwa v83, v66 dst_sel:WORD_0 dst_unused:UNUSED_PAD src0_sel:WORD_0
    v_exp_f16_sdwa v82, v65 dst_sel:WORD_1 dst_unused:UNUSED_PRESERVE src0_sel:WORD_0
    v_exp_f16_sdwa v83, v67 dst_sel:WORD_1 dst_unused:UNUSED_PRESERVE src0_sel:WORD_0
    v_mfma_f32_32x32x16_f16 v[116:131], v[28:31], v[76:79], v[116:131]
L_cand112:
    s_cbranch_vccnz L_tret
    v_exp_f16_sdwa v68, v36 dst_sel:WORD_0 dst_unused:UNUSED_PAD src0_sel:WORD_0
    v_exp_f16_sdwa v69, v38 dst_sel:WORD_0 dst_unused:UNUSED_PAD src0_sel:WORD_0
    v_exp_f16_sdwa v68, v37 dst_sel:WORD_1 dst_unused:UNUSED_PRESERVE src0_sel:WORD_0
    v_exp_f16_sdwa v69, v39 dst_sel:WORD_1 dst_unused:UNUSED_PRESERVE src0_sel:WORD_0
    v_mfma_f32_32x32x16_bf16 v[52:67], v[4:7], v[88:91], 4.0
L_cand113:
    v_exp_f16_sdwa v70, v40 dst_sel:WORD_0 dst_unused:UNUSED_PAD src0_sel:WORD_0
    v_exp_f16_sdwa v71, v42 dst_sel:WORD_0 dst_unused:UNUSED_PAD src0_sel:WORD_0
    v_exp_f16_sdwa v70, v41 dst_sel:WORD_1 dst_unused:UNUSED_PRESERVE src0_sel:WORD_0
    v_exp_f16_sdwa v71, v43 dst_sel:WORD_1 dst_unused:UNUSED_PRESERVE src0_sel:WORD_0
    v_mfma_f32_32x32x16_bf16 v[52:67], v[8:11], v[96:99], v[52:67]
L_cand114:
    v_exp_f16_sdwa v72, v44 dst_sel:WORD_0 dst_unused:UNUSED_PAD src0_sel:WORD_0
    v_exp_f16_sdwa v73, v46 dst_sel:WORD_0 dst_unused:UNUSED_PAD src0_sel:WORD_0
    v_exp_f16_sdwa v72, v45 dst_sel:WORD_1 dst_unused:UNUSED_PRESERVE src0_sel:WORD_0
    v_exp_f16_sdwa v73, v47 dst_sel:WORD_1 dst_unused:UNUSED_PRESERVE src0_sel:WORD_0
    v_mfma_f32_32x32x16_f16 v[116:131], v[32:35], v[80:83], v[116:131]
L_cand115:
    s_waitcnt lgkmcnt(0)
    v_exp_f16_sdwa v74, v48 dst_sel:WORD_0 dst_unused:UNUSED_PAD src0_sel:WORD_0
    v_exp_f16_sdwa v75, v50 dst_sel:WORD_0 dst_unused:UNUSED_PAD src0_sel:WORD_0
    v_exp_f16_sdwa v74, v49 dst_sel:WORD_1 dst_unused:UNUSED_PRESERVE src0_sel:WORD_0
    v_exp_f16_sdwa v75, v51 dst_sel:WORD_1 dst_unused:UNUSED_PRESERVE src0_sel:WORD_0
    v_mfma_f32_32x32x16_f16 v[100:115], v[20:23], v[68:71], v[100:115]
L_cand116:
    ds_read_b128 v[28:31], v1 offset:63488
    v_exp_f16_sdwa v76, v52 dst_sel:WORD_0 dst_unused:UNUSED_PAD src0_sel:WORD_0
    v_exp_f16_sdwa v77, v54 dst_sel:WORD_0 dst_unused:UNUSED_PAD src0_sel:WORD_0
    v_exp_f16_sdwa v76, v53 dst_sel:WORD_1 dst_unused:UNUSED_PRESERVE src0_sel:WORD_0
    v_exp_f16_sdwa v77, v55 dst_sel:WORD_1 dst_unused:UNUSED_PRESERVE src0_sel:WORD_0
    v_mfma_f32_32x32x16_bf16 v[36:51], v[12:15], v[84:87], 4.0
L_cand117:
    ds_read_b128 v[32:35], v1 offset:64512
    v_exp_f16_sdwa v78, v56 dst_sel:WORD_0 dst_unused:UNUSED_PAD src0_sel:WORD_0
    v_exp_f16_sdwa v79, v58 dst_sel:WORD_0 dst_unused:UNUSED_PAD src0_sel:WORD_0
    v_exp_f16_sdwa v78, v57 dst_sel:WORD_1 dst_unused:UNUSED_PRESERVE src0_sel:WORD_0
    v_exp_f16_sdwa v79, v59 dst_sel:WORD_1 dst_unused:UNUSED_PRESERVE src0_sel:WORD_0
    v_mfma_f32_32x32x16_bf16 v[36:51], v[16:19], v[92:95], v[36:51]
L_cand118:
    v_exp_f16_sdwa v80, v60 dst_sel:WORD_0 dst_unused:UNUSED_PAD src0_sel:WORD_0
    v_exp_f16_sdwa v81, v62 dst_sel:WORD_0 dst_unused:UNUSED_PAD src0_sel:WORD_0
    v_exp_f16_sdwa v80, v61 dst_sel:WORD_1 dst_unused:UNUSED_PRESERVE src0_sel:WORD_0
    v_exp_f16_sdwa v81, v63 dst_sel:WORD_1 dst_unused:UNUSED_PRESERVE src0_sel:WORD_0
    v_mfma_f32_32x32x16_f16 v[100:115], v[24:27], v[72:75], v[100:115]
L_cand119:
    v_exp_f16_sdwa v82, v64 dst_sel:WORD_0 dst_unused:UNUSED_PAD src0_sel:WORD_0
    v_exp_f16_sdwa v83, v66 dst_sel:WORD_0 dst_unused:UNUSED_PAD src0_sel:WORD_0
    v_exp_f16_sdwa v82, v65 dst_sel:WORD_1 dst_unused:UNUSED_PRESERVE src0_sel:WORD_0
    v_exp_f16_sdwa v83, v67 dst_sel:WORD_1 dst_unused:UNUSED_PRESERVE src0_sel:WORD_0
    v_mfma_f32_32x32x16_f16 v[116:131], v[20:23], v[76:79], v[116:131]
L_cand120:
    v_exp_f16_sdwa v68, v36 dst_sel:WORD_0 dst_unused:UNUSED_PAD src0_sel:WORD_0
    v_exp_f16_sdwa v69, v38 dst_sel:WORD_0 dst_unused:UNUSED_PAD src0_sel:WORD_0
    v_exp_f16_sdwa v68, v37 dst_sel:WORD_1 dst_unused:UNUSED_PRESERVE src0_sel:WORD_0
    v_exp_f16_sdwa v69, v39 dst_sel:WORD_1 dst_unused:UNUSED_PRESERVE src0_sel:WORD_0
    v_mfma_f32_32x32x16_bf16 v[52:67], v[12:15], v[88:91], 4.0
L_cand121:
    s_bitcmp1_b32 s48, s33
    v_exp_f16_sdwa v70, v40 dst_sel:WORD_0 dst_unused:UNUSED_PAD src0_sel:WORD_0
    v_exp_f16_sdwa v71, v42 dst_sel:WORD_0 dst_unused:UNUSED_PAD src0_sel:WORD_0
    v_exp_f16_sdwa v70, v41 dst_sel:WORD_1 dst_unused:UNUSED_PRESERVE src0_sel:WORD_0
    v_exp_f16_sdwa v71, v43 dst_sel:WORD_1 dst_unused:UNUSED_PRESERVE src0_sel:WORD_0
    v_mfma_f32_32x32x16_bf16 v[52:67], v[16:19], v[96:99], v[52:67]
L_cand122:
    v_exp_f16_sdwa v72, v44 dst_sel:WORD_0 dst_unused:UNUSED_PAD src0_sel:WORD_0
    v_exp_f16_sdwa v73, v46 dst_sel:WORD_0 dst_unused:UNUSED_PAD src0_sel:WORD_0
    v_exp_f16_sdwa v72, v45 dst_sel:WORD_1 dst_unused:UNUSED_PRESERVE src0_sel:WORD_0
    v_exp_f16_sdwa v73, v47 dst_sel:WORD_1 dst_unused:UNUSED_PRESERVE src0_sel:WORD_0
    v_mfma_f32_32x32x16_f16 v[116:131], v[24:27], v[80:83], v[116:131]
L_cand123:
    s_waitcnt lgkmcnt(0)
    s_cbranch_scc0 L_nobar_u15
    s_barrier
L_nobar_u15:
    v_xor_b32 v1, 65536, v1
    ds_read_b128 v[4:7], v1 offset:0
    ds_read_b128 v[8:11], v1 offset:1024
    v_exp_f16_sdwa v74, v48 dst_sel:WORD_0 dst_unused:UNUSED_PAD src0_sel:WORD_0
    v_exp_f16_sdwa v75, v50 dst_sel:WORD_0 dst_unused:UNUSED_PAD src0_sel:WORD_0
    v_exp_f16_sdwa v74, v49 dst_sel:WORD_1 dst_unused:UNUSED_PRESERVE src0_sel:WORD_0
    v_exp_f16_sdwa v75, v51 dst_sel:WORD_1 dst_unused:UNUSED_PRESERVE src0_sel:WORD_0
    v_mfma_f32_32x32x16_f16 v[100:115], v[28:31], v[68:71], v[100:115]
L_cand124:
    ds_read_b128 v[20:23], v1 offset:16384
    v_exp_f16_sdwa v76, v52 dst_sel:WORD_0 dst_unused:UNUSED_PAD src0_sel:WORD_0
    v_exp_f16_sdwa v77, v54 dst_sel:WORD_0 dst_unused:UNUSED_PAD src0_sel:WORD_0
    v_exp_f16_sdwa v76, v53 dst_sel:WORD_1 dst_unused:UNUSED_PRESERVE src0_sel:WORD_0
    v_exp_f16_sdwa v77, v55 dst_sel:WORD_1 dst_unused:UNUSED_PRESERVE src0_sel:WORD_0
    s_waitcnt lgkmcnt(1)
    v_mfma_f32_32x32x16_bf16 v[36:51], v[4:7], v[84:87], 4.0
L_cand125:
    ds_read_b128 v[24:27], v1 offset:17408
    v_exp_f16_sdwa v78, v56 dst_sel:WORD_0 dst_unused:UNUSED_PAD src0_sel:WORD_0
    v_exp_f16_sdwa v79, v58 dst_sel:WORD_0 dst_unused:UNUSED_PAD src0_sel:WORD_0
    v_exp_f16_sdwa v78, v57 dst_sel:WORD_1 dst_unused:UNUSED_PRESERVE src0_sel:WORD_0
    v_exp_f16_sdwa v79, v59 dst_sel:WORD_1 dst_unused:UNUSED_PRESERVE src0_sel:WORD_0
    v_mfma_f32_32x32x16_bf16 v[36:51], v[8:11], v[92:95], v[36:51]
L_cand126:
    ds_read_b128 v[12:15], v1 offset:2048
    v_exp_f16_sdwa v80, v60 dst_sel:WORD_0 dst_unused:UNUSED_PAD src0_sel:WORD_0
    v_exp_f16_sdwa v81, v62 dst_sel:WORD_0 dst_unused:UNUSED_PAD src0_sel:WORD_0
    v_exp_f16_sdwa v80, v61 dst_sel:WORD_1 dst_unused:UNUSED_PRESERVE src0_sel:WORD_0
    v_exp_f16_sdwa v81, v63 dst_sel:WORD_1 dst_unused:UNUSED_PRESERVE src0_sel:WORD_0
    v_mfma_f32_32x32x16_f16 v[100:115], v[32:35], v[72:75], v[100:115]
L_cand127:
    ds_read_b128 v[16:19], v1 offset:3072
    v_exp_f16_sdwa v82, v64 dst_sel:WORD_0 dst_unused:UNUSED_PAD src0_sel:WORD_0
    v_exp_f16_sdwa v83, v66 dst_sel:WORD_0 dst_unused:UNUSED_PAD src0_sel:WORD_0
    v_exp_f16_sdwa v82, v65 dst_sel:WORD_1 dst_unused:UNUSED_PRESERVE src0_sel:WORD_0
    v_exp_f16_sdwa v83, v67 dst_sel:WORD_1 dst_unused:UNUSED_PRESERVE src0_sel:WORD_0
    s_sub_u32 s33, s33, 1
    s_cmp_lg_u32 s33, 0
    s_cbranch_scc1 L_main_u
L_drain_u:
    s_nop 1
    v_mfma_f32_32x32x16_f16 v[116:131], v[28:31], v[76:79], v[116:131]
    v_mfma_f32_32x32x16_f16 v[116:131], v[32:35], v[80:83], v[116:131]
L_epilogue:
    v_mov_b32 v149, 0x207
    v_mov_b32 v132, 0x38000000
    s_nop 15
    s_nop 1
    s_cmp_eq_u32 s2, -1
L_epi0:
    v_mov_b32 v52, v112
    v_mov_b32 v53, v112
    s_nop 1
    v_permlane32_swap_b32 v52, v53
    s_cbranch_vccnz L_tret
    s_nop 0
    v_rcp_f32 v54, v53
    s_nop 0
    v_mul_f32 v100, v100, v54
    v_mul_f32 v101, v101, v54
    v_mul_f32 v102, v102, v54
    v_mul_f32 v103, v103, v54
    v_mul_f32 v104, v104, v54
    v_mul_f32 v105, v105, v54
    v_mul_f32 v106, v106, v54
    v_mul_f32 v107, v107, v54
    v_mul_f32 v108, v108, v54
    v_mul_f32 v109, v109, v54
    v_mul_f32 v110, v110, v54
    v_mul_f32 v111, v111, v54
    v_mul_f32 v112, v112, v54
    v_mul_f32 v113, v113, v54
    v_mul_f32 v114, v114, v54
    v_mul_f32 v115, v115, v54
    v_cvt_pk_bf16_f32 v36, v100, v101
    v_cvt_pk_bf16_f32 v37, v102, v103
    v_cvt_pk_bf16_f32 v38, v104, v105
    v_cvt_pk_bf16_f32 v39, v106, v107
    v_cvt_pk_bf16_f32 v40, v108, v109
    v_cvt_pk_bf16_f32 v41, v110, v111
    v_cvt_pk_bf16_f32 v42, v112, v113
    v_cvt_pk_bf16_f32 v43, v114, v115
    s_cbranch_scc1 L_hend
    ds_write_b64 v3, v[36:37] offset:0
    ds_write_b64 v3, v[38:39] offset:16
    ds_write_b64 v3, v[40:41] offset:32
    s_mov_b32 exec_hi, 0
    ds_write_b64 v3, v[42:43] offset:48
    s_mov_b32 exec_hi, -1
    v_maximum3_f32 v138, |v100|, |v101|, |v100|
    v_maximum3_f32 v138, |v102|, |v103|, |v138|
    v_maximum3_f32 v138, |v104|, |v105|, |v138|
    v_maximum3_f32 v138, |v106|, |v107|, |v138|
    v_maximum3_f32 v138, |v108|, |v109|, |v138|
    v_maximum3_f32 v138, |v110|, |v111|, |v138|
    v_maximum3_f32 v139, |v112|, |v113|, |v112|
    v_maximum3_f32 v139, |v114|, |v115|, |v139|
L_epi1:
    v_mov_b32 v52, v128
    v_mov_b32 v53, v128
    s_nop 1
    v_permlane32_swap_b32 v52, v53
    s_cbranch_vccnz L_tret
    s_nop 0
    v_rcp_f32 v54, v53
    s_nop 0
    v_mul_f32 v116, v116, v54
    v_mul_f32 v117, v117, v54
    v_mul_f32 v118, v118, v54
    v_mul_f32 v119, v119, v54
    v_mul_f32 v120, v120, v54
    v_mul_f32 v121, v121, v54
    v_mul_f32 v122, v122, v54
    v_mul_f32 v123, v123, v54
    v_mul_f32 v124, v124, v54
    v_mul_f32 v125, v125, v54
    v_mul_f32 v126, v126, v54
    v_mul_f32 v127, v127, v54
    v_mul_f32 v128, v128, v54
    v_mul_f32 v129, v129, v54
    v_mul_f32 v130, v130, v54
    v_mul_f32 v131, v131, v54
    v_cvt_pk_bf16_f32 v44, v116, v117
    v_cvt_pk_bf16_f32 v45, v118, v119
    v_cvt_pk_bf16_f32 v46, v120, v121
    v_cvt_pk_bf16_f32 v47, v122, v123
    v_cvt_pk_bf16_f32 v48, v124, v125
    v_cvt_pk_bf16_f32 v49, v126, v127
    v_cvt_pk_bf16_f32 v50, v128, v129
    v_cvt_pk_bf16_f32 v51, v130, v131
    s_cbranch_scc1 L_hend
    ds_write_b64 v3, v[44:45] offset:1792
    ds_write_b64 v3, v[46:47] offset:1808
    ds_write_b64 v3, v[48:49] offset:1824
    s_mov_b32 exec_hi, 0
    ds_write_b64 v3, v[50:51] offset:1840
    s_mov_b32 exec_hi, -1
    v_maximum3_f32 v138, |v116|, |v117|, |v138|
    v_maximum3_f32 v138, |v118|, |v119|, |v138|
    v_maximum3_f32 v138, |v120|, |v121|, |v138|
    v_maximum3_f32 v138, |v122|, |v123|, |v138|
    v_maximum3_f32 v138, |v124|, |v125|, |v138|
    v_maximum3_f32 v138, |v126|, |v127|, |v138|
    v_maximum3_f32 v139, |v128|, |v129|, |v139|
    v_maximum3_f32 v139, |v130|, |v131|, |v139|
    s_cmp_lg_u32 s32, 0
    s_cbranch_scc1 L_store
    v_cmp_nge_f32 s[90:91], v138, v132
    v_maximum3_f32 v138, v138, v139, v139
    s_cmp_eq_u64 s[90:91], -1
    s_cbranch_scc1 L_bad
    v_cmp_class_f32 vcc, v138, v149
    s_cmp_lg_u64 vcc, 0
    s_cbranch_scc1 L_bad
L_store:
    s_mov_b64 vcc, 0
    s_waitcnt lgkmcnt(0)
    ds_read_b128 v[100:103], v144 offset:0
    ds_read_b128 v[104:107], v144 offset:1024
    ds_read_b128 v[108:111], v144 offset:2048
    ds_read_b128 v[112:115], v144 offset:3072
    s_waitcnt lgkmcnt(3)
    buffer_store_dwordx4 v[100:103], v142, s[28:31], s34 offen offset:0 sc0 sc1 nt
    s_waitcnt lgkmcnt(2)
    buffer_store_dwordx4 v[104:107], v142, s[28:31], s34 offen offset:1024 sc0 sc1 nt
    s_waitcnt lgkmcnt(1)
    buffer_store_dwordx4 v[108:111], v142, s[28:31], s34 offen offset:2048 sc0 sc1 nt
    s_waitcnt lgkmcnt(0)
    s_mov_b32 exec_hi, 0
    buffer_store_dwordx4 v[112:115], v142, s[28:31], s34 offen offset:3072 sc0 sc1 nt
    s_mov_b64 exec, -1
L_fin:
L_end:
    s_endpgm
L_c1wait_u:
    ds_read_b32 v149, v137 offset:8
    s_waitcnt lgkmcnt(0)
    v_readfirstlane_b32 s18, v149
    s_nop 3
    s_cmp_eq_u32 s18, 4
    s_cbranch_scc1 L_nobar_u7
    s_sleep 1
    s_branch L_c1wait_u
L_c1wait_f:
    s_cmp_eq_u32 s33, 1
    s_cbranch_scc0 L_c1w_f
    ds_read_b32 v149, v137 offset:12
    s_waitcnt lgkmcnt(0)
    v_readfirstlane_b32 s18, v149
    s_nop 3
    s_cmp_eq_u32 s18, 1
    s_cselect_b32 s49, 1, 0
    s_branch L_nobar_f7
L_c1w_f:
    ds_read_b32 v149, v137 offset:8
    s_waitcnt lgkmcnt(0)
    v_readfirstlane_b32 s18, v149
    s_nop 3
    s_cmp_eq_u32 s18, 4
    s_cbranch_scc1 L_c1w_f2
    s_sleep 1
    s_branch L_c1w_f
L_c1w_f2:
    s_cmp_lg_u32 s51, 0
    s_cbranch_scc1 L_nobar_f7
    s_waitcnt vmcnt(0)
    v_mov_b32 v147, 1
    s_mov_b64 exec, 1
    ds_add_rtn_u32 v149, v148, v147 offset:0
    s_waitcnt lgkmcnt(0)
    v_readfirstlane_b32 s18, v149
    v_mov_b32 v147, 1
    s_nop 2
    s_cmp_eq_u32 s18, 11
    s_cbranch_scc0 L_nf2
    v_add_u32 v149, s15, v146
    buffer_store_byte v147, v149, s[96:99], 0 offen sc1
L_nf2:
    s_mov_b64 exec, -1
    s_branch L_nobar_f7
L_c1wait_s:
    ds_read_b32 v149, v137 offset:8
    s_waitcnt lgkmcnt(0)
    v_readfirstlane_b32 s18, v149
    s_nop 3
    s_cmp_eq_u32 s18, 4
    s_cbranch_scc1 L_max_nobar
    s_sleep 1
    s_branch L_c1wait_s
L_item:
    s_cmp_lt_u32 s11, s12
    s_cbranch_scc0 L_kdone
    s_lshr_b32 s19, s11, 7
    s_mov_b32 s57, s9
L_sel:
    s_cmp_eq_u32 s19, 0
    s_cbranch_scc1 L_seld
    s_sub_u32 s18, s57, 1
    s_and_b32 s57, s57, s18
    s_sub_u32 s19, s19, 1
    s_branch L_sel
L_seld:
    s_ff1_i32_b32 s57, s57
    s_bfe_u32 s18, s11, 0x20005
    s_lshl_b32 s18, s18, 4
    s_add_u32 s57, s57, s18
    s_lshl_b32 s18, s57, 19
    s_add_u32 s4, s58, s18
    s_addc_u32 s5, s59, 0
    s_and_b32 s5, s5, 0xffff
    s_mov_b32 s6, 524288
    s_mov_b32 s7, 0x00020000
    s_lshl_b32 s18, s57, 2
    v_mov_b32 v155, s18
    s_mov_b32 s45, 0
L_poll3:
    buffer_load_dword v149, v155, s[96:99], 0 offen sc1
    s_waitcnt vmcnt(0)
    v_readfirstlane_b32 s18, v149
    s_nop 3
    s_and_b32 s18, s18, 0x01010101
    s_cmp_eq_u32 s18, 0x01010101
    s_cbranch_scc1 L_go3
    s_add_u32 s45, s45, 1
    s_cmp_lt_u32 s45, 8
    s_cbranch_scc0 L_kdone
    s_sleep 8
    s_branch L_poll3
L_go3:
    s_and_b32 s57, s11, 31
    s_and_b32 s45, s44, 1
    s_lshl_b32 s18, s57, 12
    s_lshl_b32 s19, s45, 10
    s_add_u32 s18, s18, s19
    buffer_load_dwordx4 v[76:79], v142, s[4:7], s18 offen
    buffer_load_dwordx4 v[80:83], v142, s[4:7], s18 offen offset:2048
    s_lshr_b32 s18, s44, 1
    s_lshl_b32 s18, s18, 13
    s_add_u32 s18, s18, 229376
    s_add_u32 s19, s18, 4096
    buffer_load_dwordx4 v[4:7], v142, s[4:7], s18 offen offset:0
    buffer_load_dwordx4 v[8:11], v142, s[4:7], s18 offen offset:1024
    buffer_load_dwordx4 v[12:15], v142, s[4:7], s18 offen offset:2048
    buffer_load_dwordx4 v[16:19], v142, s[4:7], s18 offen offset:3072
    buffer_load_dwordx4 v[20:23], v142, s[4:7], s19 offen offset:0
    buffer_load_dwordx4 v[24:27], v142, s[4:7], s19 offen offset:1024
    buffer_load_dwordx4 v[28:31], v142, s[4:7], s19 offen offset:2048
    buffer_load_dwordx4 v[32:35], v142, s[4:7], s19 offen offset:3072
    s_add_u32 s18, s18, 16384
    s_add_u32 s19, s19, 16384
    buffer_load_dwordx4 v[84:87], v142, s[4:7], s18 offen offset:0
    buffer_load_dwordx4 v[88:91], v142, s[4:7], s18 offen offset:1024
    buffer_load_dwordx4 v[92:95], v142, s[4:7], s18 offen offset:2048
    buffer_load_dwordx4 v[96:99], v142, s[4:7], s18 offen offset:3072
    buffer_load_dwordx4 v[100:103], v142, s[4:7], s19 offen offset:0
    buffer_load_dwordx4 v[104:107], v142, s[4:7], s19 offen offset:1024
    buffer_load_dwordx4 v[108:111], v142, s[4:7], s19 offen offset:2048
    buffer_load_dwordx4 v[112:115], v142, s[4:7], s19 offen offset:3072
    s_waitcnt vmcnt(8)
    v_mfma_f32_32x32x16_f16 v[36:51], v[4:7], v[76:79], 0
    v_mfma_f32_32x32x16_f16 v[36:51], v[8:11], v[80:83], v[36:51]
    v_mfma_f32_32x32x16_f16 v[52:67], v[12:15], v[76:79], 0
    v_mfma_f32_32x32x16_f16 v[52:67], v[16:19], v[80:83], v[52:67]
    s_nop 15
    s_waitcnt vmcnt(0)
    v_exp_f32 v36, v36
    v_exp_f32 v37, v37
    v_exp_f32 v38, v38
    v_exp_f32 v39, v39
    v_cvt_pk_bf16_f32 v68, v36, v37
    v_exp_f32 v40, v40
    v_exp_f32 v41, v41
    v_cvt_pk_bf16_f32 v69, v38, v39
    v_exp_f32 v42, v42
    v_exp_f32 v43, v43
    v_cvt_pk_bf16_f32 v70, v40, v41
    v_exp_f32 v44, v44
    v_exp_f32 v45, v45
    v_cvt_pk_bf16_f32 v71, v42, v43
    v_exp_f32 v46, v46
    v_exp_f32 v47, v47
    v_cvt_pk_bf16_f32 v72, v44, v45
    v_exp_f32 v48, v48
    v_exp_f32 v49, v49
    v_cvt_pk_bf16_f32 v73, v46, v47
    v_exp_f32 v50, v50
    v_exp_f32 v51, v51
    v_cvt_pk_bf16_f32 v74, v48, v49
    s_nop 0
    v_cvt_pk_bf16_f32 v75, v50, v51
    s_nop 1
    v_mfma_f32_32x32x16_bf16 v[116:131], v[84:87], v[68:71], 0
    v_mfma_f32_32x32x16_bf16 v[116:131], v[88:91], v[72:75], v[116:131]
    v_mfma_f32_32x32x16_f16 v[36:51], v[20:23], v[76:79], 0
    v_mfma_f32_32x32x16_f16 v[36:51], v[24:27], v[80:83], v[36:51]
    s_nop 15
    v_exp_f32 v52, v52
    v_exp_f32 v53, v53
    v_exp_f32 v54, v54
    v_exp_f32 v55, v55
    v_cvt_pk_bf16_f32 v68, v52, v53
    v_exp_f32 v56, v56
    v_exp_f32 v57, v57
    v_cvt_pk_bf16_f32 v69, v54, v55
    v_exp_f32 v58, v58
    v_exp_f32 v59, v59
    v_cvt_pk_bf16_f32 v70, v56, v57
    v_exp_f32 v60, v60
    v_exp_f32 v61, v61
    v_cvt_pk_bf16_f32 v71, v58, v59
    v_exp_f32 v62, v62
    v_exp_f32 v63, v63
    v_cvt_pk_bf16_f32 v72, v60, v61
    v_exp_f32 v64, v64
    v_exp_f32 v65, v65
    v_cvt_pk_bf16_f32 v73, v62, v63
    v_exp_f32 v66, v66
    v_exp_f32 v67, v67
    v_cvt_pk_bf16_f32 v74, v64, v65
    s_nop 0
    v_cvt_pk_bf16_f32 v75, v66, v67
    s_nop 1
    v_mfma_f32_32x32x16_bf16 v[116:131], v[92:95], v[68:71], v[116:131]
    v_mfma_f32_32x32x16_bf16 v[116:131], v[96:99], v[72:75], v[116:131]
    v_mfma_f32_32x32x16_f16 v[52:67], v[28:31], v[76:79], 0
    v_mfma_f32_32x32x16_f16 v[52:67], v[32:35], v[80:83], v[52:67]
    s_nop 15
    v_exp_f32 v36, v36
    v_exp_f32 v37, v37
    v_exp_f32 v38, v38
    v_exp_f32 v39, v39
    v_cvt_pk_bf16_f32 v68, v36, v37
    v_exp_f32 v40, v40
    v_exp_f32 v41, v41
    v_cvt_pk_bf16_f32 v69, v38, v39
    v_exp_f32 v42, v42
    v_exp_f32 v43, v43
    v_cvt_pk_bf16_f32 v70, v40, v41
    v_exp_f32 v44, v44
    v_exp_f32 v45, v45
    v_cvt_pk_bf16_f32 v71, v42, v43
    v_exp_f32 v46, v46
    v_exp_f32 v47, v47
    v_cvt_pk_bf16_f32 v72, v44, v45
    v_exp_f32 v48, v48
    v_exp_f32 v49, v49
    v_cvt_pk_bf16_f32 v73, v46, v47
    v_exp_f32 v50, v50
    v_exp_f32 v51, v51
    v_cvt_pk_bf16_f32 v74, v48, v49
    s_nop 0
    v_cvt_pk_bf16_f32 v75, v50, v51
    s_nop 1
    v_mfma_f32_32x32x16_bf16 v[116:131], v[100:103], v[68:71], v[116:131]
    v_mfma_f32_32x32x16_bf16 v[116:131], v[104:107], v[72:75], v[116:131]
    s_nop 15
    v_exp_f32 v52, v52
    v_exp_f32 v53, v53
    v_exp_f32 v54, v54
    v_exp_f32 v55, v55
    v_cvt_pk_bf16_f32 v68, v52, v53
    v_exp_f32 v56, v56
    v_exp_f32 v57, v57
    v_cvt_pk_bf16_f32 v69, v54, v55
    v_exp_f32 v58, v58
    v_exp_f32 v59, v59
    v_cvt_pk_bf16_f32 v70, v56, v57
    v_exp_f32 v60, v60
    v_exp_f32 v61, v61
    v_cvt_pk_bf16_f32 v71, v58, v59
    v_exp_f32 v62, v62
    v_exp_f32 v63, v63
    v_cvt_pk_bf16_f32 v72, v60, v61
    v_exp_f32 v64, v64
    v_exp_f32 v65, v65
    v_cvt_pk_bf16_f32 v73, v62, v63
    v_exp_f32 v66, v66
    v_exp_f32 v67, v67
    v_cvt_pk_bf16_f32 v74, v64, v65
    s_nop 0
    v_cvt_pk_bf16_f32 v75, v66, v67
    s_nop 1
    v_mfma_f32_32x32x16_bf16 v[116:131], v[108:111], v[68:71], v[116:131]
    v_mfma_f32_32x32x16_bf16 v[116:131], v[112:115], v[72:75], v[116:131]
    s_nop 15
    s_lshl_b32 s19, s13, 1
    s_add_u32 s19, s19, s45
    s_lshl_b32 s18, s19, 12
    s_add_u32 s18, s18, 131072
    v_add_u32 v140, s18, v142
    s_lshl_b32 s19, s19, 2
    v_add_u32 v157, s19, v148
    v_mov_b32 v147, 1
    s_mov_b64 exec, 1
    ds_add_rtn_u32 v149, v157, v147 offset:16
    s_mov_b64 exec, -1
    s_waitcnt lgkmcnt(0)
    v_readfirstlane_b32 s18, v149
    s_nop 15
    s_nop 7
    s_cmp_eq_u32 s18, 0
    s_cbranch_scc0 L_radd
    ds_write_b128 v140, v[116:119] offset:0
    ds_write_b128 v140, v[120:123] offset:1024
    ds_write_b128 v140, v[124:127] offset:2048
    ds_write_b128 v140, v[128:131] offset:3072
    s_waitcnt lgkmcnt(0)
    ds_write_b32 v157, v147 offset:32
    s_branch L_inext
L_radd:
    ds_read_b32 v149, v157 offset:32
    s_waitcnt lgkmcnt(0)
    v_readfirstlane_b32 s18, v149
    s_nop 3
    s_cmp_lg_u32 s18, 0
    s_cbranch_scc1 L_radd2
    s_sleep 1
    s_branch L_radd
L_radd2:
    ds_read_b128 v[36:39], v140 offset:0
    ds_read_b128 v[40:43], v140 offset:1024
    ds_read_b128 v[44:47], v140 offset:2048
    ds_read_b128 v[48:51], v140 offset:3072
    s_lshl_b32 s18, s57, 13
    s_lshl_b32 s19, s45, 12
    s_add_u32 s18, s18, s19
    s_add_u32 s18, s18, 262144
    s_waitcnt lgkmcnt(3)
    v_add_f32 v116, v116, v36
    v_add_f32 v117, v117, v37
    v_add_f32 v118, v118, v38
    v_add_f32 v119, v119, v39
    buffer_store_dwordx4 v[116:119], v142, s[4:7], s18 offen offset:0 sc1
    s_waitcnt lgkmcnt(2)
    v_add_f32 v120, v120, v40
    v_add_f32 v121, v121, v41
    v_add_f32 v122, v122, v42
    v_add_f32 v123, v123, v43
    buffer_store_dwordx4 v[120:123], v142, s[4:7], s18 offen offset:1024 sc1
    s_waitcnt lgkmcnt(1)
    v_add_f32 v124, v124, v44
    v_add_f32 v125, v125, v45
    v_add_f32 v126, v126, v46
    v_add_f32 v127, v127, v47
    buffer_store_dwordx4 v[124:127], v142, s[4:7], s18 offen offset:2048 sc1
    s_waitcnt lgkmcnt(0)
    v_add_f32 v128, v128, v48
    v_add_f32 v129, v129, v49
    v_add_f32 v130, v130, v50
    v_add_f32 v131, v131, v51
    buffer_store_dwordx4 v[128:131], v142, s[4:7], s18 offen offset:3072 sc1
    s_lshr_b32 s18, s57, 3
    s_lshl_b32 s18, s18, 3
    s_lshl_b32 s18, 2, s18
    v_mov_b32 v149, s18
    s_waitcnt vmcnt(0)
    s_mov_b64 exec, 1
    buffer_atomic_add v149, v155, s[96:99], 0 offen sc1
    s_mov_b64 exec, -1
L_inext:
    s_add_u32 s11, s11, s10
    s_add_u32 s13, s13, 1
    s_branch L_kdone
L_fb:
    s_mul_i32 s57, s45, 7168
    s_mov_b32 m0, s39
    s_nop 0
    buffer_load_dwordx4 v142, s[20:23], s57 offen offset:0 lds
    buffer_load_dwordx4 v142, s[20:23], s57 offen offset:1024 lds
    buffer_load_dwordx4 v142, s[20:23], s57 offen offset:2048 lds
    s_mov_b32 exec_hi, 0
    buffer_load_dwordx4 v142, s[20:23], s57 offen offset:3072 lds
    s_mov_b32 exec_hi, -1
    s_add_u32 s45, s39, 16384
    s_mov_b32 m0, s45
    s_nop 0
    buffer_load_dwordx4 v142, s[24:27], s57 offen offset:0 lds
    buffer_load_dwordx4 v142, s[24:27], s57 offen offset:1024 lds
    buffer_load_dwordx4 v142, s[24:27], s57 offen offset:2048 lds
    s_mov_b32 exec_hi, 0
    buffer_load_dwordx4 v142, s[24:27], s57 offen offset:3072 lds
    s_mov_b32 exec_hi, -1
    s_add_u32 s57, s57, 3584
    s_add_u32 s45, s39, 4096
    s_mov_b32 m0, s45
    s_nop 0
    buffer_load_dwordx4 v142, s[20:23], s57 offen offset:0 lds
    buffer_load_dwordx4 v142, s[20:23], s57 offen offset:1024 lds
    buffer_load_dwordx4 v142, s[20:23], s57 offen offset:2048 lds
    s_mov_b32 exec_hi, 0
    buffer_load_dwordx4 v142, s[20:23], s57 offen offset:3072 lds
    s_mov_b32 exec_hi, -1
    s_add_u32 s45, s39, 20480
    s_mov_b32 m0, s45
    s_nop 0
    buffer_load_dwordx4 v142, s[24:27], s57 offen offset:0 lds
    buffer_load_dwordx4 v142, s[24:27], s57 offen offset:1024 lds
    buffer_load_dwordx4 v142, s[24:27], s57 offen offset:2048 lds
    s_mov_b32 exec_hi, 0
    buffer_load_dwordx4 v142, s[24:27], s57 offen offset:3072 lds
    s_mov_b32 exec_hi, -1
    s_branch L_blk
L_fast:
    s_cbranch_vccnz L_tret
    s_mov_b32 s49, 0
    s_or_b32 s35, s35, 2
    ds_read_b128 v[4:7], v1 offset:0
    ds_read_b128 v[8:11], v1 offset:1024
    ds_read_b128 v[20:23], v1 offset:16384
    ds_read_b128 v[24:27], v1 offset:17408
    ds_read_b128 v[12:15], v1 offset:2048
    ds_read_b128 v[16:19], v1 offset:3072
    s_waitcnt lgkmcnt(4)
    v_mfma_f32_32x32x16_f16 v[36:51], v[4:7], v[84:87], 0
    v_mfma_f32_32x32x16_f16 v[36:51], v[8:11], v[92:95], v[36:51]
    s_nop 15
L_main_f:
    v_mfma_f32_32x32x16_bf16 v[116:131], v[28:31], v[76:79], v[116:131]
L_cand128:
    s_setprio 2
    v_exp_f32 v36, v36
    v_exp_f32 v37, v37
    v_cvt_pk_bf16_f32 v83, v66, v67
    v_exp_f32 v38, v38
    v_exp_f32 v39, v39
    v_cvt_pk_bf16_f32 v68, v36, v37
    v_mfma_f32_32x32x16_f16 v[52:67], v[4:7], v[88:91], 0
L_cand129:
    v_exp_f32 v40, v40
    v_exp_f32 v41, v41
    v_cvt_pk_bf16_f32 v69, v38, v39
    v_exp_f32 v42, v42
    v_exp_f32 v43, v43
    v_cvt_pk_bf16_f32 v70, v40, v41
    v_mfma_f32_32x32x16_f16 v[52:67], v[8:11], v[96:99], v[52:67]
L_cand130:
    v_exp_f32 v44, v44
    v_exp_f32 v45, v45
    v_cvt_pk_bf16_f32 v71, v42, v43
    v_exp_f32 v46, v46
    v_exp_f32 v47, v47
    v_cvt_pk_bf16_f32 v72, v44, v45
    v_mfma_f32_32x32x16_bf16 v[116:131], v[32:35], v[80:83], v[116:131]
L_cand131:
    s_waitcnt lgkmcnt(0)
    v_exp_f32 v48, v48
    v_exp_f32 v49, v49
    v_cvt_pk_bf16_f32 v73, v46, v47
    v_exp_f32 v50, v50
    v_exp_f32 v51, v51
    v_cvt_pk_bf16_f32 v74, v48, v49
    v_mfma_f32_32x32x16_bf16 v[100:115], v[20:23], v[68:71], v[100:115]
L_cand132:
    ds_read_b128 v[28:31], v1 offset:18432
    v_exp_f32 v52, v52
    v_exp_f32 v53, v53
    v_cvt_pk_bf16_f32 v75, v50, v51
    v_exp_f32 v54, v54
    v_exp_f32 v55, v55
    v_cvt_pk_bf16_f32 v76, v52, v53
    v_mfma_f32_32x32x16_f16 v[36:51], v[12:15], v[84:87], 0
L_cand133:
    ds_read_b128 v[32:35], v1 offset:19456
    v_exp_f32 v56, v56
    v_exp_f32 v57, v57
    v_cvt_pk_bf16_f32 v77, v54, v55
    v_exp_f32 v58, v58
    v_exp_f32 v59, v59
    v_cvt_pk_bf16_f32 v78, v56, v57
    v_mfma_f32_32x32x16_f16 v[36:51], v[16:19], v[92:95], v[36:51]
L_cand134:
    ds_read_b128 v[4:7], v1 offset:4096
    v_exp_f32 v60, v60
    v_exp_f32 v61, v61
    v_cvt_pk_bf16_f32 v79, v58, v59
    v_exp_f32 v62, v62
    v_exp_f32 v63, v63
    v_cvt_pk_bf16_f32 v80, v60, v61
    v_mfma_f32_32x32x16_bf16 v[100:115], v[24:27], v[72:75], v[100:115]
L_cand135:
    ds_read_b128 v[8:11], v1 offset:5120
    v_exp_f32 v64, v64
    v_exp_f32 v65, v65
    v_cvt_pk_bf16_f32 v81, v62, v63
    v_exp_f32 v66, v66
    v_exp_f32 v67, v67
    v_cvt_pk_bf16_f32 v82, v64, v65
    v_mfma_f32_32x32x16_bf16 v[116:131], v[20:23], v[76:79], v[116:131]
L_cand136:
    v_exp_f32 v36, v36
    v_exp_f32 v37, v37
    v_cvt_pk_bf16_f32 v83, v66, v67
    v_exp_f32 v38, v38
    v_exp_f32 v39, v39
    v_cvt_pk_bf16_f32 v68, v36, v37
    v_mfma_f32_32x32x16_f16 v[52:67], v[12:15], v[88:91], 0
L_cand137:
    v_exp_f32 v40, v40
    v_exp_f32 v41, v41
    v_cvt_pk_bf16_f32 v69, v38, v39
    v_exp_f32 v42, v42
    v_exp_f32 v43, v43
    v_cvt_pk_bf16_f32 v70, v40, v41
    v_mfma_f32_32x32x16_f16 v[52:67], v[16:19], v[96:99], v[52:67]
L_cand138:
    v_exp_f32 v44, v44
    v_exp_f32 v45, v45
    v_cvt_pk_bf16_f32 v71, v42, v43
    v_exp_f32 v46, v46
    v_exp_f32 v47, v47
    v_cvt_pk_bf16_f32 v72, v44, v45
    v_mfma_f32_32x32x16_bf16 v[116:131], v[24:27], v[80:83], v[116:131]
L_cand139:
    s_waitcnt lgkmcnt(0)
    v_exp_f32 v48, v48
    v_exp_f32 v49, v49
    v_cvt_pk_bf16_f32 v73, v46, v47
    v_exp_f32 v50, v50
    v_exp_f32 v51, v51
    v_cvt_pk_bf16_f32 v74, v48, v49
    v_mfma_f32_32x32x16_bf16 v[100:115], v[28:31], v[68:71], v[100:115]
L_cand140:
    ds_read_b128 v[20:23], v1 offset:20480
    v_exp_f32 v52, v52
    v_exp_f32 v53, v53
    v_cvt_pk_bf16_f32 v75, v50, v51
    v_exp_f32 v54, v54
    v_exp_f32 v55, v55
    v_cvt_pk_bf16_f32 v76, v52, v53
    v_mfma_f32_32x32x16_f16 v[36:51], v[4:7], v[84:87], 0
L_cand141:
    ds_read_b128 v[24:27], v1 offset:21504
    v_exp_f32 v56, v56
    v_exp_f32 v57, v57
    v_cvt_pk_bf16_f32 v77, v54, v55
    v_exp_f32 v58, v58
    v_exp_f32 v59, v59
    v_cvt_pk_bf16_f32 v78, v56, v57
    v_mfma_f32_32x32x16_f16 v[36:51], v[8:11], v[92:95], v[36:51]
L_cand142:
    s_cbranch_vccnz L_tret
    ds_read_b128 v[12:15], v1 offset:6144
    v_exp_f32 v60, v60
    v_exp_f32 v61, v61
    v_cvt_pk_bf16_f32 v79, v58, v59
    v_exp_f32 v62, v62
    v_exp_f32 v63, v63
    v_cvt_pk_bf16_f32 v80, v60, v61
    v_mfma_f32_32x32x16_bf16 v[100:115], v[32:35], v[72:75], v[100:115]
L_cand143:
    ds_read_b128 v[16:19], v1 offset:7168
    v_exp_f32 v64, v64
    v_exp_f32 v65, v65
    v_cvt_pk_bf16_f32 v81, v62, v63
    v_exp_f32 v66, v66
    v_exp_f32 v67, v67
    v_cvt_pk_bf16_f32 v82, v64, v65
    v_mfma_f32_32x32x16_bf16 v[116:131], v[28:31], v[76:79], v[116:131]
L_cand144:
    v_exp_f32 v36, v36
    v_exp_f32 v37, v37
    v_cvt_pk_bf16_f32 v83, v66, v67
    v_exp_f32 v38, v38
    v_exp_f32 v39, v39
    v_cvt_pk_bf16_f32 v68, v36, v37
    v_mfma_f32_32x32x16_f16 v[52:67], v[4:7], v[88:91], 0
L_cand145:
    v_exp_f32 v40, v40
    v_exp_f32 v41, v41
    v_cvt_pk_bf16_f32 v69, v38, v39
    v_exp_f32 v42, v42
    v_exp_f32 v43, v43
    v_cvt_pk_bf16_f32 v70, v40, v41
    v_mfma_f32_32x32x16_f16 v[52:67], v[8:11], v[96:99], v[52:67]
L_cand146:
    v_exp_f32 v44, v44
    v_exp_f32 v45, v45
    v_cvt_pk_bf16_f32 v71, v42, v43
    v_exp_f32 v46, v46
    v_exp_f32 v47, v47
    v_cvt_pk_bf16_f32 v72, v44, v45
    v_mfma_f32_32x32x16_bf16 v[116:131], v[32:35], v[80:83], v[116:131]
L_cand147:
    s_waitcnt lgkmcnt(0)
    v_exp_f32 v48, v48
    v_exp_f32 v49, v49
    v_cvt_pk_bf16_f32 v73, v46, v47
    v_exp_f32 v50, v50
    v_exp_f32 v51, v51
    v_cvt_pk_bf16_f32 v74, v48, v49
    v_mfma_f32_32x32x16_bf16 v[100:115], v[20:23], v[68:71], v[100:115]
L_cand148:
    ds_read_b128 v[28:31], v1 offset:22528
    v_exp_f32 v52, v52
    v_exp_f32 v53, v53
    v_cvt_pk_bf16_f32 v75, v50, v51
    v_exp_f32 v54, v54
    v_exp_f32 v55, v55
    v_cvt_pk_bf16_f32 v76, v52, v53
    v_mfma_f32_32x32x16_f16 v[36:51], v[12:15], v[84:87], 0
L_cand149:
    ds_read_b128 v[32:35], v1 offset:23552
    v_exp_f32 v56, v56
    v_exp_f32 v57, v57
    v_cvt_pk_bf16_f32 v77, v54, v55
    v_exp_f32 v58, v58
    v_exp_f32 v59, v59
    v_cvt_pk_bf16_f32 v78, v56, v57
    v_mfma_f32_32x32x16_f16 v[36:51], v[16:19], v[92:95], v[36:51]
L_cand150:
    ds_read_b128 v[4:7], v1 offset:8192
    v_exp_f32 v60, v60
    v_exp_f32 v61, v61
    v_cvt_pk_bf16_f32 v79, v58, v59
    v_exp_f32 v62, v62
    v_exp_f32 v63, v63
    v_cvt_pk_bf16_f32 v80, v60, v61
    v_mfma_f32_32x32x16_bf16 v[100:115], v[24:27], v[72:75], v[100:115]
L_cand151:
    ds_read_b128 v[8:11], v1 offset:9216
    v_exp_f32 v64, v64
    v_exp_f32 v65, v65
    v_cvt_pk_bf16_f32 v81, v62, v63
    v_exp_f32 v66, v66
    v_exp_f32 v67, v67
    v_cvt_pk_bf16_f32 v82, v64, v65
    v_mfma_f32_32x32x16_bf16 v[116:131], v[20:23], v[76:79], v[116:131]
L_cand152:
    v_exp_f32 v36, v36
    v_exp_f32 v37, v37
    v_cvt_pk_bf16_f32 v83, v66, v67
    v_exp_f32 v38, v38
    v_exp_f32 v39, v39
    v_cvt_pk_bf16_f32 v68, v36, v37
    v_mfma_f32_32x32x16_f16 v[52:67], v[12:15], v[88:91], 0
L_cand153:
    v_exp_f32 v40, v40
    v_exp_f32 v41, v41
    v_cvt_pk_bf16_f32 v69, v38, v39
    v_exp_f32 v42, v42
    v_exp_f32 v43, v43
    v_cvt_pk_bf16_f32 v70, v40, v41
    v_mfma_f32_32x32x16_f16 v[52:67], v[16:19], v[96:99], v[52:67]
L_cand154:
    v_exp_f32 v44, v44
    v_exp_f32 v45, v45
    v_cvt_pk_bf16_f32 v71, v42, v43
    v_exp_f32 v46, v46
    v_exp_f32 v47, v47
    v_cvt_pk_bf16_f32 v72, v44, v45
    v_mfma_f32_32x32x16_bf16 v[116:131], v[24:27], v[80:83], v[116:131]
L_cand155:
    s_waitcnt lgkmcnt(0)
    v_exp_f32 v48, v48
    v_exp_f32 v49, v49
    v_cvt_pk_bf16_f32 v73, v46, v47
    v_exp_f32 v50, v50
    v_exp_f32 v51, v51
    v_cvt_pk_bf16_f32 v74, v48, v49
    v_mfma_f32_32x32x16_bf16 v[100:115], v[28:31], v[68:71], v[100:115]
L_cand156:
    ds_read_b128 v[20:23], v1 offset:24576
    v_exp_f32 v52, v52
    v_exp_f32 v53, v53
    v_cvt_pk_bf16_f32 v75, v50, v51
    v_exp_f32 v54, v54
    v_exp_f32 v55, v55
    v_cvt_pk_bf16_f32 v76, v52, v53
    v_mfma_f32_32x32x16_f16 v[36:51], v[4:7], v[84:87], 0
L_cand157:
    ds_read_b128 v[24:27], v1 offset:25600
    v_exp_f32 v56, v56
    v_exp_f32 v57, v57
    v_cvt_pk_bf16_f32 v77, v54, v55
    v_exp_f32 v58, v58
    v_exp_f32 v59, v59
    v_cvt_pk_bf16_f32 v78, v56, v57
    v_mfma_f32_32x32x16_f16 v[36:51], v[8:11], v[92:95], v[36:51]
L_cand158:
    ds_read_b128 v[12:15], v1 offset:10240
    v_exp_f32 v60, v60
    v_exp_f32 v61, v61
    v_cvt_pk_bf16_f32 v79, v58, v59
    v_exp_f32 v62, v62
    v_exp_f32 v63, v63
    v_cvt_pk_bf16_f32 v80, v60, v61
    v_mfma_f32_32x32x16_bf16 v[100:115], v[32:35], v[72:75], v[100:115]
L_cand159:
    ds_read_b128 v[16:19], v1 offset:11264
    v_exp_f32 v64, v64
    v_exp_f32 v65, v65
    v_cvt_pk_bf16_f32 v81, v62, v63
    v_exp_f32 v66, v66
    v_exp_f32 v67, v67
    v_cvt_pk_bf16_f32 v82, v64, v65
    v_mfma_f32_32x32x16_bf16 v[116:131], v[28:31], v[76:79], v[116:131]
L_cand160:
    v_exp_f32 v36, v36
    v_exp_f32 v37, v37
    v_cvt_pk_bf16_f32 v83, v66, v67
    v_exp_f32 v38, v38
    v_exp_f32 v39, v39
    v_cvt_pk_bf16_f32 v68, v36, v37
    v_mfma_f32_32x32x16_f16 v[52:67], v[4:7], v[88:91], 0
L_cand161:
    v_exp_f32 v40, v40
    v_exp_f32 v41, v41
    v_cvt_pk_bf16_f32 v69, v38, v39
    v_exp_f32 v42, v42
    v_exp_f32 v43, v43
    v_cvt_pk_bf16_f32 v70, v40, v41
    v_mfma_f32_32x32x16_f16 v[52:67], v[8:11], v[96:99], v[52:67]
L_cand162:
    v_exp_f32 v44, v44
    v_exp_f32 v45, v45
    v_cvt_pk_bf16_f32 v71, v42, v43
    v_exp_f32 v46, v46
    v_exp_f32 v47, v47
    v_cvt_pk_bf16_f32 v72, v44, v45
    v_mfma_f32_32x32x16_bf16 v[116:131], v[32:35], v[80:83], v[116:131]
L_cand163:
    s_waitcnt lgkmcnt(0)
    v_exp_f32 v48, v48
    v_exp_f32 v49, v49
    v_cvt_pk_bf16_f32 v73, v46, v47
    v_exp_f32 v50, v50
    v_exp_f32 v51, v51
    v_cvt_pk_bf16_f32 v74, v48, v49
    v_mfma_f32_32x32x16_bf16 v[100:115], v[20:23], v[68:71], v[100:115]
L_cand164:
    s_cbranch_vccnz L_tret
    ds_read_b128 v[28:31], v1 offset:26624
    v_exp_f32 v52, v52
    v_exp_f32 v53, v53
    v_cvt_pk_bf16_f32 v75, v50, v51
    v_exp_f32 v54, v54
    v_exp_f32 v55, v55
    v_cvt_pk_bf16_f32 v76, v52, v53
    v_mfma_f32_32x32x16_f16 v[36:51], v[12:15], v[84:87], 0
L_cand165:
    ds_read_b128 v[32:35], v1 offset:27648
    v_exp_f32 v56, v56
    v_exp_f32 v57, v57
    v_cvt_pk_bf16_f32 v77, v54, v55
    v_exp_f32 v58, v58
    v_exp_f32 v59, v59
    v_cvt_pk_bf16_f32 v78, v56, v57
    v_mfma_f32_32x32x16_f16 v[36:51], v[16:19], v[92:95], v[36:51]
L_cand166:
    ds_read_b128 v[4:7], v1 offset:12288
    v_exp_f32 v60, v60
    v_exp_f32 v61, v61
    v_cvt_pk_bf16_f32 v79, v58, v59
    v_exp_f32 v62, v62
    v_exp_f32 v63, v63
    v_cvt_pk_bf16_f32 v80, v60, v61
    v_mfma_f32_32x32x16_bf16 v[100:115], v[24:27], v[72:75], v[100:115]
L_cand167:
    ds_read_b128 v[8:11], v1 offset:13312
    v_exp_f32 v64, v64
    v_exp_f32 v65, v65
    v_cvt_pk_bf16_f32 v81, v62, v63
    v_exp_f32 v66, v66
    v_exp_f32 v67, v67
    v_cvt_pk_bf16_f32 v82, v64, v65
    v_mfma_f32_32x32x16_bf16 v[116:131], v[20:23], v[76:79], v[116:131]
L_cand168:
    v_exp_f32 v36, v36
    v_exp_f32 v37, v37
    v_cvt_pk_bf16_f32 v83, v66, v67
    v_exp_f32 v38, v38
    v_exp_f32 v39, v39
    v_cvt_pk_bf16_f32 v68, v36, v37
    v_mfma_f32_32x32x16_f16 v[52:67], v[12:15], v[88:91], 0
L_cand169:
    v_exp_f32 v40, v40
    v_exp_f32 v41, v41
    v_cvt_pk_bf16_f32 v69, v38, v39
    v_exp_f32 v42, v42
    v_exp_f32 v43, v43
    v_cvt_pk_bf16_f32 v70, v40, v41
    v_mfma_f32_32x32x16_f16 v[52:67], v[16:19], v[96:99], v[52:67]
L_cand170:
    v_exp_f32 v44, v44
    v_exp_f32 v45, v45
    v_cvt_pk_bf16_f32 v71, v42, v43
    v_exp_f32 v46, v46
    v_exp_f32 v47, v47
    v_cvt_pk_bf16_f32 v72, v44, v45
    v_mfma_f32_32x32x16_bf16 v[116:131], v[24:27], v[80:83], v[116:131]
L_cand171:
    s_waitcnt lgkmcnt(0)
    v_exp_f32 v48, v48
    v_exp_f32 v49, v49
    v_cvt_pk_bf16_f32 v73, v46, v47
    v_exp_f32 v50, v50
    v_exp_f32 v51, v51
    v_cvt_pk_bf16_f32 v74, v48, v49
    v_mfma_f32_32x32x16_bf16 v[100:115], v[28:31], v[68:71], v[100:115]
L_cand172:
    ds_read_b128 v[20:23], v1 offset:28672
    v_exp_f32 v52, v52
    v_exp_f32 v53, v53
    v_cvt_pk_bf16_f32 v75, v50, v51
    v_exp_f32 v54, v54
    v_exp_f32 v55, v55
    v_cvt_pk_bf16_f32 v76, v52, v53
    v_mfma_f32_32x32x16_f16 v[36:51], v[4:7], v[84:87], 0
L_cand173:
    ds_read_b128 v[24:27], v1 offset:29696
    v_exp_f32 v56, v56
    v_exp_f32 v57, v57
    v_cvt_pk_bf16_f32 v77, v54, v55
    v_exp_f32 v58, v58
    v_exp_f32 v59, v59
    v_cvt_pk_bf16_f32 v78, v56, v57
    v_mfma_f32_32x32x16_f16 v[36:51], v[8:11], v[92:95], v[36:51]
L_cand174:
    ds_read_b128 v[12:15], v1 offset:14336
    v_exp_f32 v60, v60
    v_exp_f32 v61, v61
    v_cvt_pk_bf16_f32 v79, v58, v59
    v_exp_f32 v62, v62
    v_exp_f32 v63, v63
    v_cvt_pk_bf16_f32 v80, v60, v61
    v_mfma_f32_32x32x16_bf16 v[100:115], v[32:35], v[72:75], v[100:115]
L_cand175:
    ds_read_b128 v[16:19], v1 offset:15360
    v_exp_f32 v64, v64
    v_exp_f32 v65, v65
    v_cvt_pk_bf16_f32 v81, v62, v63
    v_exp_f32 v66, v66
    v_exp_f32 v67, v67
    v_cvt_pk_bf16_f32 v82, v64, v65
    v_mfma_f32_32x32x16_bf16 v[116:131], v[28:31], v[76:79], v[116:131]
L_cand176:
    s_setprio 1
    v_exp_f32 v36, v36
    v_exp_f32 v37, v37
    v_cvt_pk_bf16_f32 v83, v66, v67
    v_exp_f32 v38, v38
    v_exp_f32 v39, v39
    v_cvt_pk_bf16_f32 v68, v36, v37
    v_mfma_f32_32x32x16_f16 v[52:67], v[4:7], v[88:91], 0
L_cand177:
    v_exp_f32 v40, v40
    v_exp_f32 v41, v41
    v_cvt_pk_bf16_f32 v69, v38, v39
    v_exp_f32 v42, v42
    v_exp_f32 v43, v43
    v_cvt_pk_bf16_f32 v70, v40, v41
    v_mfma_f32_32x32x16_f16 v[52:67], v[8:11], v[96:99], v[52:67]
L_cand178:
    v_exp_f32 v44, v44
    v_exp_f32 v45, v45
    v_cvt_pk_bf16_f32 v71, v42, v43
    v_exp_f32 v46, v46
    v_exp_f32 v47, v47
    v_cvt_pk_bf16_f32 v72, v44, v45
    v_mfma_f32_32x32x16_bf16 v[116:131], v[32:35], v[80:83], v[116:131]
L_cand179:
    s_waitcnt lgkmcnt(0)
    v_exp_f32 v48, v48
    v_exp_f32 v49, v49
    v_cvt_pk_bf16_f32 v73, v46, v47
    v_exp_f32 v50, v50
    v_exp_f32 v51, v51
    v_cvt_pk_bf16_f32 v74, v48, v49
    v_mfma_f32_32x32x16_bf16 v[100:115], v[20:23], v[68:71], v[100:115]
L_cand180:
    ds_read_b128 v[28:31], v1 offset:30720
    v_exp_f32 v52, v52
    v_exp_f32 v53, v53
    v_cvt_pk_bf16_f32 v75, v50, v51
    v_exp_f32 v54, v54
    v_exp_f32 v55, v55
    v_cvt_pk_bf16_f32 v76, v52, v53
    v_mfma_f32_32x32x16_f16 v[36:51], v[12:15], v[84:87], 0
L_cand181:
    ds_read_b128 v[32:35], v1 offset:31744
    v_exp_f32 v56, v56
    v_exp_f32 v57, v57
    v_cvt_pk_bf16_f32 v77, v54, v55
    v_exp_f32 v58, v58
    v_exp_f32 v59, v59
    v_cvt_pk_bf16_f32 v78, v56, v57
    v_mfma_f32_32x32x16_f16 v[36:51], v[16:19], v[92:95], v[36:51]
L_cand182:
    v_exp_f32 v60, v60
    v_exp_f32 v61, v61
    v_cvt_pk_bf16_f32 v79, v58, v59
    v_exp_f32 v62, v62
    v_exp_f32 v63, v63
    v_cvt_pk_bf16_f32 v80, v60, v61
    v_mfma_f32_32x32x16_bf16 v[100:115], v[24:27], v[72:75], v[100:115]
L_cand183:
    v_exp_f32 v64, v64
    v_exp_f32 v65, v65
    v_cvt_pk_bf16_f32 v81, v62, v63
    v_exp_f32 v66, v66
    v_exp_f32 v67, v67
    v_cvt_pk_bf16_f32 v82, v64, v65
    v_mfma_f32_32x32x16_bf16 v[116:131], v[20:23], v[76:79], v[116:131]
L_cand184:
    v_exp_f32 v36, v36
    v_exp_f32 v37, v37
    v_cvt_pk_bf16_f32 v83, v66, v67
    v_exp_f32 v38, v38
    v_exp_f32 v39, v39
    v_cvt_pk_bf16_f32 v68, v36, v37
    v_mfma_f32_32x32x16_f16 v[52:67], v[12:15], v[88:91], 0
L_cand185:
    s_bitcmp1_b32 s35, s33
    v_exp_f32 v40, v40
    v_exp_f32 v41, v41
    v_cvt_pk_bf16_f32 v69, v38, v39
    v_exp_f32 v42, v42
    v_exp_f32 v43, v43
    v_cvt_pk_bf16_f32 v70, v40, v41
    v_mfma_f32_32x32x16_f16 v[52:67], v[16:19], v[96:99], v[52:67]
L_cand186:
    v_exp_f32 v44, v44
    v_exp_f32 v45, v45
    v_cvt_pk_bf16_f32 v71, v42, v43
    v_exp_f32 v46, v46
    v_exp_f32 v47, v47
    v_cvt_pk_bf16_f32 v72, v44, v45
    v_mfma_f32_32x32x16_bf16 v[116:131], v[24:27], v[80:83], v[116:131]
L_cand187:
    s_waitcnt lgkmcnt(0)
    s_cbranch_scc0 L_nobar_f7
    s_branch L_c1wait_f
L_nobar_f7:
    ds_read_b128 v[4:7], v1 offset:32768
    ds_read_b128 v[8:11], v1 offset:33792
    v_exp_f32 v48, v48
    v_exp_f32 v49, v49
    v_cvt_pk_bf16_f32 v73, v46, v47
    v_exp_f32 v50, v50
    v_exp_f32 v51, v51
    v_cvt_pk_bf16_f32 v74, v48, v49
    v_mfma_f32_32x32x16_bf16 v[100:115], v[28:31], v[68:71], v[100:115]
L_cand188:
    ds_read_b128 v[20:23], v1 offset:49152
    v_exp_f32 v52, v52
    v_exp_f32 v53, v53
    v_cvt_pk_bf16_f32 v75, v50, v51
    v_exp_f32 v54, v54
    v_exp_f32 v55, v55
    v_cvt_pk_bf16_f32 v76, v52, v53
    s_waitcnt lgkmcnt(1)
    v_mfma_f32_32x32x16_f16 v[36:51], v[4:7], v[84:87], 0
L_cand189:
    ds_read_b128 v[24:27], v1 offset:50176
    v_exp_f32 v56, v56
    v_exp_f32 v57, v57
    v_cvt_pk_bf16_f32 v77, v54, v55
    v_exp_f32 v58, v58
    v_exp_f32 v59, v59
    v_cvt_pk_bf16_f32 v78, v56, v57
    v_mfma_f32_32x32x16_f16 v[36:51], v[8:11], v[92:95], v[36:51]
L_cand190:
    ds_read_b128 v[12:15], v1 offset:34816
    v_exp_f32 v60, v60
    v_exp_f32 v61, v61
    v_cvt_pk_bf16_f32 v79, v58, v59
    v_exp_f32 v62, v62
    v_exp_f32 v63, v63
    v_cvt_pk_bf16_f32 v80, v60, v61
    v_mfma_f32_32x32x16_bf16 v[100:115], v[32:35], v[72:75], v[100:115]
L_cand191:
    ds_read_b128 v[16:19], v1 offset:35840
    v_exp_f32 v64, v64
    v_exp_f32 v65, v65
    v_cvt_pk_bf16_f32 v81, v62, v63
    v_exp_f32 v66, v66
    v_exp_f32 v67, v67
    v_cvt_pk_bf16_f32 v82, v64, v65
    s_cmp_eq_u32 s49, s33
    s_cbranch_scc1 L_drain_f
    v_mfma_f32_32x32x16_bf16 v[116:131], v[28:31], v[76:79], v[116:131]
L_cand192:
    v_exp_f32 v36, v36
    v_exp_f32 v37, v37
    v_cvt_pk_bf16_f32 v83, v66, v67
    v_exp_f32 v38, v38
    v_exp_f32 v39, v39
    v_cvt_pk_bf16_f32 v68, v36, v37
    v_mfma_f32_32x32x16_f16 v[52:67], v[4:7], v[88:91], 0
L_cand193:
    s_cbranch_vccnz L_tret
    v_exp_f32 v40, v40
    v_exp_f32 v41, v41
    v_cvt_pk_bf16_f32 v69, v38, v39
    v_exp_f32 v42, v42
    v_exp_f32 v43, v43
    v_cvt_pk_bf16_f32 v70, v40, v41
    v_mfma_f32_32x32x16_f16 v[52:67], v[8:11], v[96:99], v[52:67]
L_cand194:
    v_exp_f32 v44, v44
    v_exp_f32 v45, v45
    v_cvt_pk_bf16_f32 v71, v42, v43
    v_exp_f32 v46, v46
    v_exp_f32 v47, v47
    v_cvt_pk_bf16_f32 v72, v44, v45
    v_mfma_f32_32x32x16_bf16 v[116:131], v[32:35], v[80:83], v[116:131]
L_cand195:
    s_waitcnt lgkmcnt(0)
    v_exp_f32 v48, v48
    v_exp_f32 v49, v49
    v_cvt_pk_bf16_f32 v73, v46, v47
    v_exp_f32 v50, v50
    v_exp_f32 v51, v51
    v_cvt_pk_bf16_f32 v74, v48, v49
    v_mfma_f32_32x32x16_bf16 v[100:115], v[20:23], v[68:71], v[100:115]
L_cand196:
    ds_read_b128 v[28:31], v1 offset:51200
    v_exp_f32 v52, v52
    v_exp_f32 v53, v53
    v_cvt_pk_bf16_f32 v75, v50, v51
    v_exp_f32 v54, v54
    v_exp_f32 v55, v55
    v_cvt_pk_bf16_f32 v76, v52, v53
    v_mfma_f32_32x32x16_f16 v[36:51], v[12:15], v[84:87], 0
L_cand197:
    ds_read_b128 v[32:35], v1 offset:52224
    v_exp_f32 v56, v56
    v_exp_f32 v57, v57
    v_cvt_pk_bf16_f32 v77, v54, v55
    v_exp_f32 v58, v58
    v_exp_f32 v59, v59
    v_cvt_pk_bf16_f32 v78, v56, v57
    v_mfma_f32_32x32x16_f16 v[36:51], v[16:19], v[92:95], v[36:51]
L_cand198:
    ds_read_b128 v[4:7], v1 offset:36864
    v_exp_f32 v60, v60
    v_exp_f32 v61, v61
    v_cvt_pk_bf16_f32 v79, v58, v59
    v_exp_f32 v62, v62
    v_exp_f32 v63, v63
    v_cvt_pk_bf16_f32 v80, v60, v61
    v_mfma_f32_32x32x16_bf16 v[100:115], v[24:27], v[72:75], v[100:115]
L_cand199:
    ds_read_b128 v[8:11], v1 offset:37888
    v_exp_f32 v64, v64
    v_exp_f32 v65, v65
    v_cvt_pk_bf16_f32 v81, v62, v63
    v_exp_f32 v66, v66
    v_exp_f32 v67, v67
    v_cvt_pk_bf16_f32 v82, v64, v65
    v_mfma_f32_32x32x16_bf16 v[116:131], v[20:23], v[76:79], v[116:131]
L_cand200:
    v_exp_f32 v36, v36
    v_exp_f32 v37, v37
    v_cvt_pk_bf16_f32 v83, v66, v67
    v_exp_f32 v38, v38
    v_exp_f32 v39, v39
    v_cvt_pk_bf16_f32 v68, v36, v37
    v_mfma_f32_32x32x16_f16 v[52:67], v[12:15], v[88:91], 0
L_cand201:
    v_exp_f32 v40, v40
    v_exp_f32 v41, v41
    v_cvt_pk_bf16_f32 v69, v38, v39
    v_exp_f32 v42, v42
    v_exp_f32 v43, v43
    v_cvt_pk_bf16_f32 v70, v40, v41
    v_mfma_f32_32x32x16_f16 v[52:67], v[16:19], v[96:99], v[52:67]
L_cand202:
    v_exp_f32 v44, v44
    v_exp_f32 v45, v45
    v_cvt_pk_bf16_f32 v71, v42, v43
    v_exp_f32 v46, v46
    v_exp_f32 v47, v47
    v_cvt_pk_bf16_f32 v72, v44, v45
    v_mfma_f32_32x32x16_bf16 v[116:131], v[24:27], v[80:83], v[116:131]
L_cand203:
    s_waitcnt lgkmcnt(0)
    v_exp_f32 v48, v48
    v_exp_f32 v49, v49
    v_cvt_pk_bf16_f32 v73, v46, v47
    v_exp_f32 v50, v50
    v_exp_f32 v51, v51
    v_cvt_pk_bf16_f32 v74, v48, v49
    v_mfma_f32_32x32x16_bf16 v[100:115], v[28:31], v[68:71], v[100:115]
L_cand204:
    ds_read_b128 v[20:23], v1 offset:53248
    v_exp_f32 v52, v52
    v_exp_f32 v53, v53
    v_cvt_pk_bf16_f32 v75, v50, v51
    v_exp_f32 v54, v54
    v_exp_f32 v55, v55
    v_cvt_pk_bf16_f32 v76, v52, v53
    v_mfma_f32_32x32x16_f16 v[36:51], v[4:7], v[84:87], 0
L_cand205:
    ds_read_b128 v[24:27], v1 offset:54272
    v_exp_f32 v56, v56
    v_exp_f32 v57, v57
    v_cvt_pk_bf16_f32 v77, v54, v55
    v_exp_f32 v58, v58
    v_exp_f32 v59, v59
    v_cvt_pk_bf16_f32 v78, v56, v57
    v_mfma_f32_32x32x16_f16 v[36:51], v[8:11], v[92:95], v[36:51]
L_cand206:
    ds_read_b128 v[12:15], v1 offset:38912
    v_exp_f32 v60, v60
    v_exp_f32 v61, v61
    v_cvt_pk_bf16_f32 v79, v58, v59
    v_exp_f32 v62, v62
    v_exp_f32 v63, v63
    v_cvt_pk_bf16_f32 v80, v60, v61
    v_mfma_f32_32x32x16_bf16 v[100:115], v[32:35], v[72:75], v[100:115]
L_cand207:
    ds_read_b128 v[16:19], v1 offset:39936
    v_exp_f32 v64, v64
    v_exp_f32 v65, v65
    v_cvt_pk_bf16_f32 v81, v62, v63
    v_exp_f32 v66, v66
    v_exp_f32 v67, v67
    v_cvt_pk_bf16_f32 v82, v64, v65
    v_mfma_f32_32x32x16_bf16 v[116:131], v[28:31], v[76:79], v[116:131]
L_cand208:
    v_exp_f32 v36, v36
    v_exp_f32 v37, v37
    v_cvt_pk_bf16_f32 v83, v66, v67
    v_exp_f32 v38, v38
    v_exp_f32 v39, v39
    v_cvt_pk_bf16_f32 v68, v36, v37
    v_mfma_f32_32x32x16_f16 v[52:67], v[4:7], v[88:91], 0
L_cand209:
    v_exp_f32 v40, v40
    v_exp_f32 v41, v41
    v_cvt_pk_bf16_f32 v69, v38, v39
    v_exp_f32 v42, v42
    v_exp_f32 v43, v43
    v_cvt_pk_bf16_f32 v70, v40, v41
    v_mfma_f32_32x32x16_f16 v[52:67], v[8:11], v[96:99], v[52:67]
L_cand210:
    v_exp_f32 v44, v44
    v_exp_f32 v45, v45
    v_cvt_pk_bf16_f32 v71, v42, v43
    v_exp_f32 v46, v46
    v_exp_f32 v47, v47
    v_cvt_pk_bf16_f32 v72, v44, v45
    v_mfma_f32_32x32x16_bf16 v[116:131], v[32:35], v[80:83], v[116:131]
L_cand211:
    s_waitcnt lgkmcnt(0)
    v_exp_f32 v48, v48
    v_exp_f32 v49, v49
    v_cvt_pk_bf16_f32 v73, v46, v47
    v_exp_f32 v50, v50
    v_exp_f32 v51, v51
    v_cvt_pk_bf16_f32 v74, v48, v49
    v_mfma_f32_32x32x16_bf16 v[100:115], v[20:23], v[68:71], v[100:115]
L_cand212:
    ds_read_b128 v[28:31], v1 offset:55296
    v_exp_f32 v52, v52
    v_exp_f32 v53, v53
    v_cvt_pk_bf16_f32 v75, v50, v51
    v_exp_f32 v54, v54
    v_exp_f32 v55, v55
    v_cvt_pk_bf16_f32 v76, v52, v53
    v_mfma_f32_32x32x16_f16 v[36:51], v[12:15], v[84:87], 0
L_cand213:
    ds_read_b128 v[32:35], v1 offset:56320
    v_exp_f32 v56, v56
    v_exp_f32 v57, v57
    v_cvt_pk_bf16_f32 v77, v54, v55
    v_exp_f32 v58, v58
    v_exp_f32 v59, v59
    v_cvt_pk_bf16_f32 v78, v56, v57
    v_mfma_f32_32x32x16_f16 v[36:51], v[16:19], v[92:95], v[36:51]
L_cand214:
    ds_read_b128 v[4:7], v1 offset:40960
    v_exp_f32 v60, v60
    v_exp_f32 v61, v61
    v_cvt_pk_bf16_f32 v79, v58, v59
    v_exp_f32 v62, v62
    v_exp_f32 v63, v63
    v_cvt_pk_bf16_f32 v80, v60, v61
    v_mfma_f32_32x32x16_bf16 v[100:115], v[24:27], v[72:75], v[100:115]
L_cand215:
    ds_read_b128 v[8:11], v1 offset:41984
    v_exp_f32 v64, v64
    v_exp_f32 v65, v65
    v_cvt_pk_bf16_f32 v81, v62, v63
    v_exp_f32 v66, v66
    v_exp_f32 v67, v67
    v_cvt_pk_bf16_f32 v82, v64, v65
    v_mfma_f32_32x32x16_bf16 v[116:131], v[20:23], v[76:79], v[116:131]
L_cand216:
    v_exp_f32 v36, v36
    v_exp_f32 v37, v37
    v_cvt_pk_bf16_f32 v83, v66, v67
    v_exp_f32 v38, v38
    v_exp_f32 v39, v39
    v_cvt_pk_bf16_f32 v68, v36, v37
    v_mfma_f32_32x32x16_f16 v[52:67], v[12:15], v[88:91], 0
L_cand217:
    v_exp_f32 v40, v40
    v_exp_f32 v41, v41
    v_cvt_pk_bf16_f32 v69, v38, v39
    v_exp_f32 v42, v42
    v_exp_f32 v43, v43
    v_cvt_pk_bf16_f32 v70, v40, v41
    v_mfma_f32_32x32x16_f16 v[52:67], v[16:19], v[96:99], v[52:67]
L_cand218:
    v_exp_f32 v44, v44
    v_exp_f32 v45, v45
    v_cvt_pk_bf16_f32 v71, v42, v43
    v_exp_f32 v46, v46
    v_exp_f32 v47, v47
    v_cvt_pk_bf16_f32 v72, v44, v45
    v_mfma_f32_32x32x16_bf16 v[116:131], v[24:27], v[80:83], v[116:131]
L_cand219:
    s_waitcnt lgkmcnt(0)
    v_exp_f32 v48, v48
    v_exp_f32 v49, v49
    v_cvt_pk_bf16_f32 v73, v46, v47
    v_exp_f32 v50, v50
    v_exp_f32 v51, v51
    v_cvt_pk_bf16_f32 v74, v48, v49
    v_mfma_f32_32x32x16_bf16 v[100:115], v[28:31], v[68:71], v[100:115]
L_cand220:
    ds_read_b128 v[20:23], v1 offset:57344
    v_exp_f32 v52, v52
    v_exp_f32 v53, v53
    v_cvt_pk_bf16_f32 v75, v50, v51
    v_exp_f32 v54, v54
    v_exp_f32 v55, v55
    v_cvt_pk_bf16_f32 v76, v52, v53
    v_mfma_f32_32x32x16_f16 v[36:51], v[4:7], v[84:87], 0
L_cand221:
    ds_read_b128 v[24:27], v1 offset:58368
    v_exp_f32 v56, v56
    v_exp_f32 v57, v57
    v_cvt_pk_bf16_f32 v77, v54, v55
    v_exp_f32 v58, v58
    v_exp_f32 v59, v59
    v_cvt_pk_bf16_f32 v78, v56, v57
    v_mfma_f32_32x32x16_f16 v[36:51], v[8:11], v[92:95], v[36:51]
L_cand222:
    s_cbranch_vccnz L_tret
    ds_read_b128 v[12:15], v1 offset:43008
    v_exp_f32 v60, v60
    v_exp_f32 v61, v61
    v_cvt_pk_bf16_f32 v79, v58, v59
    v_exp_f32 v62, v62
    v_exp_f32 v63, v63
    v_cvt_pk_bf16_f32 v80, v60, v61
    v_mfma_f32_32x32x16_bf16 v[100:115], v[32:35], v[72:75], v[100:115]
L_cand223:
    ds_read_b128 v[16:19], v1 offset:44032
    v_exp_f32 v64, v64
    v_exp_f32 v65, v65
    v_cvt_pk_bf16_f32 v81, v62, v63
    v_exp_f32 v66, v66
    v_exp_f32 v67, v67
    v_cvt_pk_bf16_f32 v82, v64, v65
    v_mfma_f32_32x32x16_bf16 v[116:131], v[28:31], v[76:79], v[116:131]
L_cand224:
    s_setprio 0
    v_exp_f32 v36, v36
    v_exp_f32 v37, v37
    v_cvt_pk_bf16_f32 v83, v66, v67
    v_exp_f32 v38, v38
    v_exp_f32 v39, v39
    v_cvt_pk_bf16_f32 v68, v36, v37
    v_mfma_f32_32x32x16_f16 v[52:67], v[4:7], v[88:91], 0
L_cand225:
    v_exp_f32 v40, v40
    v_exp_f32 v41, v41
    v_cvt_pk_bf16_f32 v69, v38, v39
    v_exp_f32 v42, v42
    v_exp_f32 v43, v43
    v_cvt_pk_bf16_f32 v70, v40, v41
    v_mfma_f32_32x32x16_f16 v[52:67], v[8:11], v[96:99], v[52:67]
L_cand226:
    v_exp_f32 v44, v44
    v_exp_f32 v45, v45
    v_cvt_pk_bf16_f32 v71, v42, v43
    v_exp_f32 v46, v46
    v_exp_f32 v47, v47
    v_cvt_pk_bf16_f32 v72, v44, v45
    v_mfma_f32_32x32x16_bf16 v[116:131], v[32:35], v[80:83], v[116:131]
L_cand227:
    s_waitcnt lgkmcnt(0)
    v_exp_f32 v48, v48
    v_exp_f32 v49, v49
    v_cvt_pk_bf16_f32 v73, v46, v47
    v_exp_f32 v50, v50
    v_exp_f32 v51, v51
    v_cvt_pk_bf16_f32 v74, v48, v49
    v_mfma_f32_32x32x16_bf16 v[100:115], v[20:23], v[68:71], v[100:115]
L_cand228:
    ds_read_b128 v[28:31], v1 offset:59392
    v_exp_f32 v52, v52
    v_exp_f32 v53, v53
    v_cvt_pk_bf16_f32 v75, v50, v51
    v_exp_f32 v54, v54
    v_exp_f32 v55, v55
    v_cvt_pk_bf16_f32 v76, v52, v53
    v_mfma_f32_32x32x16_f16 v[36:51], v[12:15], v[84:87], 0
L_cand229:
    ds_read_b128 v[32:35], v1 offset:60416
    v_exp_f32 v56, v56
    v_exp_f32 v57, v57
    v_cvt_pk_bf16_f32 v77, v54, v55
    v_exp_f32 v58, v58
    v_exp_f32 v59, v59
    v_cvt_pk_bf16_f32 v78, v56, v57
    v_mfma_f32_32x32x16_f16 v[36:51], v[16:19], v[92:95], v[36:51]
L_cand230:
    ds_read_b128 v[4:7], v1 offset:45056
    v_exp_f32 v60, v60
    v_exp_f32 v61, v61
    v_cvt_pk_bf16_f32 v79, v58, v59
    v_exp_f32 v62, v62
    v_exp_f32 v63, v63
    v_cvt_pk_bf16_f32 v80, v60, v61
    v_mfma_f32_32x32x16_bf16 v[100:115], v[24:27], v[72:75], v[100:115]
L_cand231:
    ds_read_b128 v[8:11], v1 offset:46080
    v_exp_f32 v64, v64
    v_exp_f32 v65, v65
    v_cvt_pk_bf16_f32 v81, v62, v63
    v_exp_f32 v66, v66
    v_exp_f32 v67, v67
    v_cvt_pk_bf16_f32 v82, v64, v65
    v_mfma_f32_32x32x16_bf16 v[116:131], v[20:23], v[76:79], v[116:131]
L_cand232:
    v_exp_f32 v36, v36
    v_exp_f32 v37, v37
    v_cvt_pk_bf16_f32 v83, v66, v67
    v_exp_f32 v38, v38
    v_exp_f32 v39, v39
    v_cvt_pk_bf16_f32 v68, v36, v37
    v_mfma_f32_32x32x16_f16 v[52:67], v[12:15], v[88:91], 0
L_cand233:
    v_exp_f32 v40, v40
    v_exp_f32 v41, v41
    v_cvt_pk_bf16_f32 v69, v38, v39
    v_exp_f32 v42, v42
    v_exp_f32 v43, v43
    v_cvt_pk_bf16_f32 v70, v40, v41
    v_mfma_f32_32x32x16_f16 v[52:67], v[16:19], v[96:99], v[52:67]
L_cand234:
    v_exp_f32 v44, v44
    v_exp_f32 v45, v45
    v_cvt_pk_bf16_f32 v71, v42, v43
    v_exp_f32 v46, v46
    v_exp_f32 v47, v47
    v_cvt_pk_bf16_f32 v72, v44, v45
    v_mfma_f32_32x32x16_bf16 v[116:131], v[24:27], v[80:83], v[116:131]
L_cand235:
    s_waitcnt lgkmcnt(0)
    v_exp_f32 v48, v48
    v_exp_f32 v49, v49
    v_cvt_pk_bf16_f32 v73, v46, v47
    v_exp_f32 v50, v50
    v_exp_f32 v51, v51
    v_cvt_pk_bf16_f32 v74, v48, v49
    v_mfma_f32_32x32x16_bf16 v[100:115], v[28:31], v[68:71], v[100:115]
L_cand236:
    ds_read_b128 v[20:23], v1 offset:61440
    v_exp_f32 v52, v52
    v_exp_f32 v53, v53
    v_cvt_pk_bf16_f32 v75, v50, v51
    v_exp_f32 v54, v54
    v_exp_f32 v55, v55
    v_cvt_pk_bf16_f32 v76, v52, v53
    v_mfma_f32_32x32x16_f16 v[36:51], v[4:7], v[84:87], 0
L_cand237:
    ds_read_b128 v[24:27], v1 offset:62464
    v_exp_f32 v56, v56
    v_exp_f32 v57, v57
    v_cvt_pk_bf16_f32 v77, v54, v55
    v_exp_f32 v58, v58
    v_exp_f32 v59, v59
    v_cvt_pk_bf16_f32 v78, v56, v57
    v_mfma_f32_32x32x16_f16 v[36:51], v[8:11], v[92:95], v[36:51]
L_cand238:
    ds_read_b128 v[12:15], v1 offset:47104
    v_exp_f32 v60, v60
    v_exp_f32 v61, v61
    v_cvt_pk_bf16_f32 v79, v58, v59
    v_exp_f32 v62, v62
    v_exp_f32 v63, v63
    v_cvt_pk_bf16_f32 v80, v60, v61
    v_mfma_f32_32x32x16_bf16 v[100:115], v[32:35], v[72:75], v[100:115]
L_cand239:
    ds_read_b128 v[16:19], v1 offset:48128
    v_exp_f32 v64, v64
    v_exp_f32 v65, v65
    v_cvt_pk_bf16_f32 v81, v62, v63
    v_exp_f32 v66, v66
    v_exp_f32 v67, v67
    v_cvt_pk_bf16_f32 v82, v64, v65
    v_mfma_f32_32x32x16_bf16 v[116:131], v[28:31], v[76:79], v[116:131]
L_cand240:
    v_exp_f32 v36, v36
    v_exp_f32 v37, v37
    v_cvt_pk_bf16_f32 v83, v66, v67
    v_exp_f32 v38, v38
    v_exp_f32 v39, v39
    v_cvt_pk_bf16_f32 v68, v36, v37
    v_mfma_f32_32x32x16_f16 v[52:67], v[4:7], v[88:91], 0
L_cand241:
    v_exp_f32 v40, v40
    v_exp_f32 v41, v41
    v_cvt_pk_bf16_f32 v69, v38, v39
    v_exp_f32 v42, v42
    v_exp_f32 v43, v43
    v_cvt_pk_bf16_f32 v70, v40, v41
    v_mfma_f32_32x32x16_f16 v[52:67], v[8:11], v[96:99], v[52:67]
L_cand242:
    v_exp_f32 v44, v44
    v_exp_f32 v45, v45
    v_cvt_pk_bf16_f32 v71, v42, v43
    v_exp_f32 v46, v46
    v_exp_f32 v47, v47
    v_cvt_pk_bf16_f32 v72, v44, v45
    v_mfma_f32_32x32x16_bf16 v[116:131], v[32:35], v[80:83], v[116:131]
L_cand243:
    s_waitcnt lgkmcnt(0)
    v_exp_f32 v48, v48
    v_exp_f32 v49, v49
    v_cvt_pk_bf16_f32 v73, v46, v47
    v_exp_f32 v50, v50
    v_exp_f32 v51, v51
    v_cvt_pk_bf16_f32 v74, v48, v49
    v_mfma_f32_32x32x16_bf16 v[100:115], v[20:23], v[68:71], v[100:115]
L_cand244:
    ds_read_b128 v[28:31], v1 offset:63488
    v_exp_f32 v52, v52
    v_exp_f32 v53, v53
    v_cvt_pk_bf16_f32 v75, v50, v51
    v_exp_f32 v54, v54
    v_exp_f32 v55, v55
    v_cvt_pk_bf16_f32 v76, v52, v53
    v_mfma_f32_32x32x16_f16 v[36:51], v[12:15], v[84:87], 0
L_cand245:
    ds_read_b128 v[32:35], v1 offset:64512
    v_exp_f32 v56, v56
    v_exp_f32 v57, v57
    v_cvt_pk_bf16_f32 v77, v54, v55
    v_exp_f32 v58, v58
    v_exp_f32 v59, v59
    v_cvt_pk_bf16_f32 v78, v56, v57
    v_mfma_f32_32x32x16_f16 v[36:51], v[16:19], v[92:95], v[36:51]
L_cand246:
    v_exp_f32 v60, v60
    v_exp_f32 v61, v61
    v_cvt_pk_bf16_f32 v79, v58, v59
    v_exp_f32 v62, v62
    v_exp_f32 v63, v63
    v_cvt_pk_bf16_f32 v80, v60, v61
    v_mfma_f32_32x32x16_bf16 v[100:115], v[24:27], v[72:75], v[100:115]
L_cand247:
    v_exp_f32 v64, v64
    v_exp_f32 v65, v65
    v_cvt_pk_bf16_f32 v81, v62, v63
    v_exp_f32 v66, v66
    v_exp_f32 v67, v67
    v_cvt_pk_bf16_f32 v82, v64, v65
    v_mfma_f32_32x32x16_bf16 v[116:131], v[20:23], v[76:79], v[116:131]
L_cand248:
    v_exp_f32 v36, v36
    v_exp_f32 v37, v37
    v_cvt_pk_bf16_f32 v83, v66, v67
    v_exp_f32 v38, v38
    v_exp_f32 v39, v39
    v_cvt_pk_bf16_f32 v68, v36, v37
    v_mfma_f32_32x32x16_f16 v[52:67], v[12:15], v[88:91], 0
L_cand249:
    s_cbranch_vccnz L_tret
    s_bitcmp1_b32 s48, s33
    v_exp_f32 v40, v40
    v_exp_f32 v41, v41
    v_cvt_pk_bf16_f32 v69, v38, v39
    v_exp_f32 v42, v42
    v_exp_f32 v43, v43
    v_cvt_pk_bf16_f32 v70, v40, v41
    v_mfma_f32_32x32x16_f16 v[52:67], v[16:19], v[96:99], v[52:67]
L_cand250:
    v_exp_f32 v44, v44
    v_exp_f32 v45, v45
    v_cvt_pk_bf16_f32 v71, v42, v43
    v_exp_f32 v46, v46
    v_exp_f32 v47, v47
    v_cvt_pk_bf16_f32 v72, v44, v45
    v_mfma_f32_32x32x16_bf16 v[116:131], v[24:27], v[80:83], v[116:131]
L_cand251:
    s_waitcnt lgkmcnt(0)
    s_cbranch_scc0 L_nobar_f15
    s_barrier
L_nobar_f15:
    v_xor_b32 v1, 65536, v1
    ds_read_b128 v[4:7], v1 offset:0
    ds_read_b128 v[8:11], v1 offset:1024
    v_exp_f32 v48, v48
    v_exp_f32 v49, v49
    v_cvt_pk_bf16_f32 v73, v46, v47
    v_exp_f32 v50, v50
    v_exp_f32 v51, v51
    v_cvt_pk_bf16_f32 v74, v48, v49
    v_mfma_f32_32x32x16_bf16 v[100:115], v[28:31], v[68:71], v[100:115]
L_cand252:
    ds_read_b128 v[20:23], v1 offset:16384
    v_exp_f32 v52, v52
    v_exp_f32 v53, v53
    v_cvt_pk_bf16_f32 v75, v50, v51
    v_exp_f32 v54, v54
    v_exp_f32 v55, v55
    v_cvt_pk_bf16_f32 v76, v52, v53
    s_waitcnt lgkmcnt(1)
    v_mfma_f32_32x32x16_f16 v[36:51], v[4:7], v[84:87], 0
L_cand253:
    ds_read_b128 v[24:27], v1 offset:17408
    v_exp_f32 v56, v56
    v_exp_f32 v57, v57
    v_cvt_pk_bf16_f32 v77, v54, v55
    v_exp_f32 v58, v58
    v_exp_f32 v59, v59
    v_cvt_pk_bf16_f32 v78, v56, v57
    v_mfma_f32_32x32x16_f16 v[36:51], v[8:11], v[92:95], v[36:51]
L_cand254:
    ds_read_b128 v[12:15], v1 offset:2048
    v_exp_f32 v60, v60
    v_exp_f32 v61, v61
    v_cvt_pk_bf16_f32 v79, v58, v59
    v_exp_f32 v62, v62
    v_exp_f32 v63, v63
    v_cvt_pk_bf16_f32 v80, v60, v61
    v_mfma_f32_32x32x16_bf16 v[100:115], v[32:35], v[72:75], v[100:115]
L_cand255:
    ds_read_b128 v[16:19], v1 offset:3072
    v_exp_f32 v64, v64
    v_exp_f32 v65, v65
    v_cvt_pk_bf16_f32 v81, v62, v63
    v_exp_f32 v66, v66
    v_exp_f32 v67, v67
    v_cvt_pk_bf16_f32 v82, v64, v65
    s_sub_u32 s33, s33, 1
    s_cmp_lg_u32 s33, 0
    s_cbranch_scc1 L_main_f
L_drain_f:
    v_cvt_pk_bf16_f32 v83, v66, v67
    s_nop 1
    v_mfma_f32_32x32x16_bf16 v[116:131], v[28:31], v[76:79], v[116:131]
    v_mfma_f32_32x32x16_bf16 v[116:131], v[32:35], v[80:83], v[116:131]
    s_cmp_eq_u32 s49, 0
    s_cbranch_scc1 L_epilogue
    s_lshl_b32 s19, s44, 13
    s_add_u32 s19, s19, 98304
    s_cmp_lt_u32 s16, 4
    s_cbranch_scc1 L_padd
    s_sub_u32 s19, s19, 65536
L_plw:
    ds_read_b32 v149, v137 offset:48
    s_waitcnt lgkmcnt(0)
    v_readfirstlane_b32 s18, v149
    s_nop 3
    s_cmp_eq_u32 s18, 4
    s_cbranch_scc1 L_padd
    s_sleep 1
    s_branch L_plw
L_padd:
    s_cbranch_vccnz L_tret
    v_add_u32 v149, s19, v142
    ds_read_b128 v[36:39], v149 offset:0
    ds_read_b128 v[40:43], v149 offset:1024
    ds_read_b128 v[44:47], v149 offset:2048
    ds_read_b128 v[48:51], v149 offset:3072
    ds_read_b128 v[52:55], v149 offset:4096
    ds_read_b128 v[56:59], v149 offset:5120
    ds_read_b128 v[60:63], v149 offset:6144
    ds_read_b128 v[64:67], v149 offset:7168
    s_nop 7
    s_waitcnt lgkmcnt(7)
    v_add_f32 v100, v100, v36
    v_add_f32 v101, v101, v37
    v_add_f32 v102, v102, v38
    v_add_f32 v103, v103, v39
    s_waitcnt lgkmcnt(6)
    v_add_f32 v104, v104, v40
    v_add_f32 v105, v105, v41
    v_add_f32 v106, v106, v42
    v_add_f32 v107, v107, v43
    s_waitcnt lgkmcnt(5)
    v_add_f32 v108, v108, v44
    v_add_f32 v109, v109, v45
    v_add_f32 v110, v110, v46
    v_add_f32 v111, v111, v47
    s_waitcnt lgkmcnt(4)
    v_add_f32 v112, v112, v48
    v_add_f32 v113, v113, v49
    v_add_f32 v114, v114, v50
    v_add_f32 v115, v115, v51
    s_waitcnt lgkmcnt(3)
    v_add_f32 v116, v116, v52
    v_add_f32 v117, v117, v53
    v_add_f32 v118, v118, v54
    v_add_f32 v119, v119, v55
    s_waitcnt lgkmcnt(2)
    v_add_f32 v120, v120, v56
    v_add_f32 v121, v121, v57
    v_add_f32 v122, v122, v58
    v_add_f32 v123, v123, v59
    s_waitcnt lgkmcnt(1)
    v_add_f32 v124, v124, v60
    v_add_f32 v125, v125, v61
    v_add_f32 v126, v126, v62
    v_add_f32 v127, v127, v63
    s_waitcnt lgkmcnt(0)
    v_add_f32 v128, v128, v64
    v_add_f32 v129, v129, v65
    v_add_f32 v130, v130, v66
    v_add_f32 v131, v131, v67
    s_branch L_epilogue
L_slow:
    v_mov_b32 v132, 0xff800000
    v_mov_b32 v133, 0xff800000
    s_mov_b32 s33, 8
    s_mov_b32 s35, 0x54
L_max_chunk:
    s_cmp_eq_u32 s33, 7
    s_cbranch_scc1 L_c1wait_s
    s_bitcmp1_b32 s35, s33
    s_cbranch_scc0 L_max_nobar
    s_barrier
L_max_nobar:
    ds_read_b128 v[4:7], v1 offset:0
    ds_read_b128 v[8:11], v1 offset:1024
    s_waitcnt lgkmcnt(0)
    v_mfma_f32_32x32x16_f16 v[36:51], v[4:7], v[84:87], 0
    v_mfma_f32_32x32x16_f16 v[36:51], v[8:11], v[92:95], v[36:51]
    s_nop 15
    s_nop 3
    v_mul_f32 v36, v36, v134
    v_max_f32 v132, v132, v36
    v_mul_f32 v37, v37, v134
    v_max_f32 v132, v132, v37
    v_mul_f32 v38, v38, v134
    v_max_f32 v132, v132, v38
    v_mul_f32 v39, v39, v134
    v_max_f32 v132, v132, v39
    v_mul_f32 v40, v40, v134
    v_max_f32 v132, v132, v40
    v_mul_f32 v41, v41, v134
    v_max_f32 v132, v132, v41
    v_mul_f32 v42, v42, v134
    v_max_f32 v132, v132, v42
    v_mul_f32 v43, v43, v134
    v_max_f32 v132, v132, v43
    v_mul_f32 v44, v44, v134
    v_max_f32 v132, v132, v44
    v_mul_f32 v45, v45, v134
    v_max_f32 v132, v132, v45
    v_mul_f32 v46, v46, v134
    v_max_f32 v132, v132, v46
    v_mul_f32 v47, v47, v134
    v_max_f32 v132, v132, v47
    v_mul_f32 v48, v48, v134
    v_max_f32 v132, v132, v48
    v_mul_f32 v49, v49, v134
    v_max_f32 v132, v132, v49
    v_mul_f32 v50, v50, v134
    v_max_f32 v132, v132, v50
    v_mul_f32 v51, v51, v134
    v_max_f32 v132, v132, v51
    s_nop 7
    v_mfma_f32_32x32x16_f16 v[36:51], v[4:7], v[88:91], 0
    v_mfma_f32_32x32x16_f16 v[36:51], v[8:11], v[96:99], v[36:51]
    s_nop 15
    s_nop 3
    v_mul_f32 v36, v36, v134
    v_max_f32 v133, v133, v36
    v_mul_f32 v37, v37, v134
    v_max_f32 v133, v133, v37
    v_mul_f32 v38, v38, v134
    v_max_f32 v133, v133, v38
    v_mul_f32 v39, v39, v134
    v_max_f32 v133, v133, v39
    v_mul_f32 v40, v40, v134
    v_max_f32 v133, v133, v40
    v_mul_f32 v41, v41, v134
    v_max_f32 v133, v133, v41
    v_mul_f32 v42, v42, v134
    v_max_f32 v133, v133, v42
    v_mul_f32 v43, v43, v134
    v_max_f32 v133, v133, v43
    v_mul_f32 v44, v44, v134
    v_max_f32 v133, v133, v44
    v_mul_f32 v45, v45, v134
    v_max_f32 v133, v133, v45
    v_mul_f32 v46, v46, v134
    v_max_f32 v133, v133, v46
    v_mul_f32 v47, v47, v134
    v_max_f32 v133, v133, v47
    v_mul_f32 v48, v48, v134
    v_max_f32 v133, v133, v48
    v_mul_f32 v49, v49, v134
    v_max_f32 v133, v133, v49
    v_mul_f32 v50, v50, v134
    v_max_f32 v133, v133, v50
    v_mul_f32 v51, v51, v134
    v_max_f32 v133, v133, v51
    s_nop 7
    ds_read_b128 v[4:7], v1 offset:2048
    ds_read_b128 v[8:11], v1 offset:3072
    s_waitcnt lgkmcnt(0)
    v_mfma_f32_32x32x16_f16 v[36:51], v[4:7], v[84:87], 0
    v_mfma_f32_32x32x16_f16 v[36:51], v[8:11], v[92:95], v[36:51]
    s_nop 15
    s_nop 3
    v_mul_f32 v36, v36, v134
    v_max_f32 v132, v132, v36
    v_mul_f32 v37, v37, v134
    v_max_f32 v132, v132, v37
    v_mul_f32 v38, v38, v134
    v_max_f32 v132, v132, v38
    v_mul_f32 v39, v39, v134
    v_max_f32 v132, v132, v39
    v_mul_f32 v40, v40, v134
    v_max_f32 v132, v132, v40
    v_mul_f32 v41, v41, v134
    v_max_f32 v132, v132, v41
    v_mul_f32 v42, v42, v134
    v_max_f32 v132, v132, v42
    v_mul_f32 v43, v43, v134
    v_max_f32 v132, v132, v43
    v_mul_f32 v44, v44, v134
    v_max_f32 v132, v132, v44
    v_mul_f32 v45, v45, v134
    v_max_f32 v132, v132, v45
    v_mul_f32 v46, v46, v134
    v_max_f32 v132, v132, v46
    v_mul_f32 v47, v47, v134
    v_max_f32 v132, v132, v47
    v_mul_f32 v48, v48, v134
    v_max_f32 v132, v132, v48
    v_mul_f32 v49, v49, v134
    v_max_f32 v132, v132, v49
    v_mul_f32 v50, v50, v134
    v_max_f32 v132, v132, v50
    v_mul_f32 v51, v51, v134
    v_max_f32 v132, v132, v51
    s_nop 7
    v_mfma_f32_32x32x16_f16 v[36:51], v[4:7], v[88:91], 0
    v_mfma_f32_32x32x16_f16 v[36:51], v[8:11], v[96:99], v[36:51]
    s_nop 15
    s_nop 3
    v_mul_f32 v36, v36, v134
    v_max_f32 v133, v133, v36
    v_mul_f32 v37, v37, v134
    v_max_f32 v133, v133, v37
    v_mul_f32 v38, v38, v134
    v_max_f32 v133, v133, v38
    v_mul_f32 v39, v39, v134
    v_max_f32 v133, v133, v39
    v_mul_f32 v40, v40, v134
    v_max_f32 v133, v133, v40
    v_mul_f32 v41, v41, v134
    v_max_f32 v133, v133, v41
    v_mul_f32 v42, v42, v134
    v_max_f32 v133, v133, v42
    v_mul_f32 v43, v43, v134
    v_max_f32 v133, v133, v43
    v_mul_f32 v44, v44, v134
    v_max_f32 v133, v133, v44
    v_mul_f32 v45, v45, v134
    v_max_f32 v133, v133, v45
    v_mul_f32 v46, v46, v134
    v_max_f32 v133, v133, v46
    v_mul_f32 v47, v47, v134
    v_max_f32 v133, v133, v47
    v_mul_f32 v48, v48, v134
    v_max_f32 v133, v133, v48
    v_mul_f32 v49, v49, v134
    v_max_f32 v133, v133, v49
    v_mul_f32 v50, v50, v134
    v_max_f32 v133, v133, v50
    v_mul_f32 v51, v51, v134
    v_max_f32 v133, v133, v51
    s_nop 7
    ds_read_b128 v[4:7], v1 offset:4096
    ds_read_b128 v[8:11], v1 offset:5120
    s_waitcnt lgkmcnt(0)
    v_mfma_f32_32x32x16_f16 v[36:51], v[4:7], v[84:87], 0
    v_mfma_f32_32x32x16_f16 v[36:51], v[8:11], v[92:95], v[36:51]
    s_nop 15
    s_nop 3
    v_mul_f32 v36, v36, v134
    v_max_f32 v132, v132, v36
    v_mul_f32 v37, v37, v134
    v_max_f32 v132, v132, v37
    v_mul_f32 v38, v38, v134
    v_max_f32 v132, v132, v38
    v_mul_f32 v39, v39, v134
    v_max_f32 v132, v132, v39
    v_mul_f32 v40, v40, v134
    v_max_f32 v132, v132, v40
    v_mul_f32 v41, v41, v134
    v_max_f32 v132, v132, v41
    v_mul_f32 v42, v42, v134
    v_max_f32 v132, v132, v42
    v_mul_f32 v43, v43, v134
    v_max_f32 v132, v132, v43
    v_mul_f32 v44, v44, v134
    v_max_f32 v132, v132, v44
    v_mul_f32 v45, v45, v134
    v_max_f32 v132, v132, v45
    v_mul_f32 v46, v46, v134
    v_max_f32 v132, v132, v46
    v_mul_f32 v47, v47, v134
    v_max_f32 v132, v132, v47
    v_mul_f32 v48, v48, v134
    v_max_f32 v132, v132, v48
    v_mul_f32 v49, v49, v134
    v_max_f32 v132, v132, v49
    v_mul_f32 v50, v50, v134
    v_max_f32 v132, v132, v50
    v_mul_f32 v51, v51, v134
    v_max_f32 v132, v132, v51
    s_nop 7
    v_mfma_f32_32x32x16_f16 v[36:51], v[4:7], v[88:91], 0
    v_mfma_f32_32x32x16_f16 v[36:51], v[8:11], v[96:99], v[36:51]
    s_nop 15
    s_nop 3
    v_mul_f32 v36, v36, v134
    v_max_f32 v133, v133, v36
    v_mul_f32 v37, v37, v134
    v_max_f32 v133, v133, v37
    v_mul_f32 v38, v38, v134
    v_max_f32 v133, v133, v38
    v_mul_f32 v39, v39, v134
    v_max_f32 v133, v133, v39
    v_mul_f32 v40, v40, v134
    v_max_f32 v133, v133, v40
    v_mul_f32 v41, v41, v134
    v_max_f32 v133, v133, v41
    v_mul_f32 v42, v42, v134
    v_max_f32 v133, v133, v42
    v_mul_f32 v43, v43, v134
    v_max_f32 v133, v133, v43
    v_mul_f32 v44, v44, v134
    v_max_f32 v133, v133, v44
    v_mul_f32 v45, v45, v134
    v_max_f32 v133, v133, v45
    v_mul_f32 v46, v46, v134
    v_max_f32 v133, v133, v46
    v_mul_f32 v47, v47, v134
    v_max_f32 v133, v133, v47
    v_mul_f32 v48, v48, v134
    v_max_f32 v133, v133, v48
    v_mul_f32 v49, v49, v134
    v_max_f32 v133, v133, v49
    v_mul_f32 v50, v50, v134
    v_max_f32 v133, v133, v50
    v_mul_f32 v51, v51, v134
    v_max_f32 v133, v133, v51
    s_nop 7
    ds_read_b128 v[4:7], v1 offset:6144
    ds_read_b128 v[8:11], v1 offset:7168
    s_waitcnt lgkmcnt(0)
    v_mfma_f32_32x32x16_f16 v[36:51], v[4:7], v[84:87], 0
    v_mfma_f32_32x32x16_f16 v[36:51], v[8:11], v[92:95], v[36:51]
    s_nop 15
    s_nop 3
    v_mul_f32 v36, v36, v134
    v_max_f32 v132, v132, v36
    v_mul_f32 v37, v37, v134
    v_max_f32 v132, v132, v37
    v_mul_f32 v38, v38, v134
    v_max_f32 v132, v132, v38
    v_mul_f32 v39, v39, v134
    v_max_f32 v132, v132, v39
    v_mul_f32 v40, v40, v134
    v_max_f32 v132, v132, v40
    v_mul_f32 v41, v41, v134
    v_max_f32 v132, v132, v41
    v_mul_f32 v42, v42, v134
    v_max_f32 v132, v132, v42
    v_mul_f32 v43, v43, v134
    v_max_f32 v132, v132, v43
    v_mul_f32 v44, v44, v134
    v_max_f32 v132, v132, v44
    v_mul_f32 v45, v45, v134
    v_max_f32 v132, v132, v45
    v_mul_f32 v46, v46, v134
    v_max_f32 v132, v132, v46
    v_mul_f32 v47, v47, v134
    v_max_f32 v132, v132, v47
    v_mul_f32 v48, v48, v134
    v_max_f32 v132, v132, v48
    v_mul_f32 v49, v49, v134
    v_max_f32 v132, v132, v49
    v_mul_f32 v50, v50, v134
    v_max_f32 v132, v132, v50
    v_mul_f32 v51, v51, v134
    v_max_f32 v132, v132, v51
    s_nop 7
    v_mfma_f32_32x32x16_f16 v[36:51], v[4:7], v[88:91], 0
    v_mfma_f32_32x32x16_f16 v[36:51], v[8:11], v[96:99], v[36:51]
    s_nop 15
    s_nop 3
    v_mul_f32 v36, v36, v134
    v_max_f32 v133, v133, v36
    v_mul_f32 v37, v37, v134
    v_max_f32 v133, v133, v37
    v_mul_f32 v38, v38, v134
    v_max_f32 v133, v133, v38
    v_mul_f32 v39, v39, v134
    v_max_f32 v133, v133, v39
    v_mul_f32 v40, v40, v134
    v_max_f32 v133, v133, v40
    v_mul_f32 v41, v41, v134
    v_max_f32 v133, v133, v41
    v_mul_f32 v42, v42, v134
    v_max_f32 v133, v133, v42
    v_mul_f32 v43, v43, v134
    v_max_f32 v133, v133, v43
    v_mul_f32 v44, v44, v134
    v_max_f32 v133, v133, v44
    v_mul_f32 v45, v45, v134
    v_max_f32 v133, v133, v45
    v_mul_f32 v46, v46, v134
    v_max_f32 v133, v133, v46
    v_mul_f32 v47, v47, v134
    v_max_f32 v133, v133, v47
    v_mul_f32 v48, v48, v134
    v_max_f32 v133, v133, v48
    v_mul_f32 v49, v49, v134
    v_max_f32 v133, v133, v49
    v_mul_f32 v50, v50, v134
    v_max_f32 v133, v133, v50
    v_mul_f32 v51, v51, v134
    v_max_f32 v133, v133, v51
    s_nop 7
    ds_read_b128 v[4:7], v1 offset:8192
    ds_read_b128 v[8:11], v1 offset:9216
    s_waitcnt lgkmcnt(0)
    v_mfma_f32_32x32x16_f16 v[36:51], v[4:7], v[84:87], 0
    v_mfma_f32_32x32x16_f16 v[36:51], v[8:11], v[92:95], v[36:51]
    s_nop 15
    s_nop 3
    v_mul_f32 v36, v36, v134
    v_max_f32 v132, v132, v36
    v_mul_f32 v37, v37, v134
    v_max_f32 v132, v132, v37
    v_mul_f32 v38, v38, v134
    v_max_f32 v132, v132, v38
    v_mul_f32 v39, v39, v134
    v_max_f32 v132, v132, v39
    v_mul_f32 v40, v40, v134
    v_max_f32 v132, v132, v40
    v_mul_f32 v41, v41, v134
    v_max_f32 v132, v132, v41
    v_mul_f32 v42, v42, v134
    v_max_f32 v132, v132, v42
    v_mul_f32 v43, v43, v134
    v_max_f32 v132, v132, v43
    v_mul_f32 v44, v44, v134
    v_max_f32 v132, v132, v44
    v_mul_f32 v45, v45, v134
    v_max_f32 v132, v132, v45
    v_mul_f32 v46, v46, v134
    v_max_f32 v132, v132, v46
    v_mul_f32 v47, v47, v134
    v_max_f32 v132, v132, v47
    v_mul_f32 v48, v48, v134
    v_max_f32 v132, v132, v48
    v_mul_f32 v49, v49, v134
    v_max_f32 v132, v132, v49
    v_mul_f32 v50, v50, v134
    v_max_f32 v132, v132, v50
    v_mul_f32 v51, v51, v134
    v_max_f32 v132, v132, v51
    s_nop 7
    v_mfma_f32_32x32x16_f16 v[36:51], v[4:7], v[88:91], 0
    v_mfma_f32_32x32x16_f16 v[36:51], v[8:11], v[96:99], v[36:51]
    s_nop 15
    s_nop 3
    v_mul_f32 v36, v36, v134
    v_max_f32 v133, v133, v36
    v_mul_f32 v37, v37, v134
    v_max_f32 v133, v133, v37
    v_mul_f32 v38, v38, v134
    v_max_f32 v133, v133, v38
    v_mul_f32 v39, v39, v134
    v_max_f32 v133, v133, v39
    v_mul_f32 v40, v40, v134
    v_max_f32 v133, v133, v40
    v_mul_f32 v41, v41, v134
    v_max_f32 v133, v133, v41
    v_mul_f32 v42, v42, v134
    v_max_f32 v133, v133, v42
    v_mul_f32 v43, v43, v134
    v_max_f32 v133, v133, v43
    v_mul_f32 v44, v44, v134
    v_max_f32 v133, v133, v44
    v_mul_f32 v45, v45, v134
    v_max_f32 v133, v133, v45
    v_mul_f32 v46, v46, v134
    v_max_f32 v133, v133, v46
    v_mul_f32 v47, v47, v134
    v_max_f32 v133, v133, v47
    v_mul_f32 v48, v48, v134
    v_max_f32 v133, v133, v48
    v_mul_f32 v49, v49, v134
    v_max_f32 v133, v133, v49
    v_mul_f32 v50, v50, v134
    v_max_f32 v133, v133, v50
    v_mul_f32 v51, v51, v134
    v_max_f32 v133, v133, v51
    s_nop 7
    ds_read_b128 v[4:7], v1 offset:10240
    ds_read_b128 v[8:11], v1 offset:11264
    s_waitcnt lgkmcnt(0)
    v_mfma_f32_32x32x16_f16 v[36:51], v[4:7], v[84:87], 0
    v_mfma_f32_32x32x16_f16 v[36:51], v[8:11], v[92:95], v[36:51]
    s_nop 15
    s_nop 3
    v_mul_f32 v36, v36, v134
    v_max_f32 v132, v132, v36
    v_mul_f32 v37, v37, v134
    v_max_f32 v132, v132, v37
    v_mul_f32 v38, v38, v134
    v_max_f32 v132, v132, v38
    v_mul_f32 v39, v39, v134
    v_max_f32 v132, v132, v39
    v_mul_f32 v40, v40, v134
    v_max_f32 v132, v132, v40
    v_mul_f32 v41, v41, v134
    v_max_f32 v132, v132, v41
    v_mul_f32 v42, v42, v134
    v_max_f32 v132, v132, v42
    v_mul_f32 v43, v43, v134
    v_max_f32 v132, v132, v43
    v_mul_f32 v44, v44, v134
    v_max_f32 v132, v132, v44
    v_mul_f32 v45, v45, v134
    v_max_f32 v132, v132, v45
    v_mul_f32 v46, v46, v134
    v_max_f32 v132, v132, v46
    v_mul_f32 v47, v47, v134
    v_max_f32 v132, v132, v47
    v_mul_f32 v48, v48, v134
    v_max_f32 v132, v132, v48
    v_mul_f32 v49, v49, v134
    v_max_f32 v132, v132, v49
    v_mul_f32 v50, v50, v134
    v_max_f32 v132, v132, v50
    v_mul_f32 v51, v51, v134
    v_max_f32 v132, v132, v51
    s_nop 7
    v_mfma_f32_32x32x16_f16 v[36:51], v[4:7], v[88:91], 0
    v_mfma_f32_32x32x16_f16 v[36:51], v[8:11], v[96:99], v[36:51]
    s_nop 15
    s_nop 3
    v_mul_f32 v36, v36, v134
    v_max_f32 v133, v133, v36
    v_mul_f32 v37, v37, v134
    v_max_f32 v133, v133, v37
    v_mul_f32 v38, v38, v134
    v_max_f32 v133, v133, v38
    v_mul_f32 v39, v39, v134
    v_max_f32 v133, v133, v39
    v_mul_f32 v40, v40, v134
    v_max_f32 v133, v133, v40
    v_mul_f32 v41, v41, v134
    v_max_f32 v133, v133, v41
    v_mul_f32 v42, v42, v134
    v_max_f32 v133, v133, v42
    v_mul_f32 v43, v43, v134
    v_max_f32 v133, v133, v43
    v_mul_f32 v44, v44, v134
    v_max_f32 v133, v133, v44
    v_mul_f32 v45, v45, v134
    v_max_f32 v133, v133, v45
    v_mul_f32 v46, v46, v134
    v_max_f32 v133, v133, v46
    v_mul_f32 v47, v47, v134
    v_max_f32 v133, v133, v47
    v_mul_f32 v48, v48, v134
    v_max_f32 v133, v133, v48
    v_mul_f32 v49, v49, v134
    v_max_f32 v133, v133, v49
    v_mul_f32 v50, v50, v134
    v_max_f32 v133, v133, v50
    v_mul_f32 v51, v51, v134
    v_max_f32 v133, v133, v51
    s_nop 7
    ds_read_b128 v[4:7], v1 offset:12288
    ds_read_b128 v[8:11], v1 offset:13312
    s_waitcnt lgkmcnt(0)
    v_mfma_f32_32x32x16_f16 v[36:51], v[4:7], v[84:87], 0
    v_mfma_f32_32x32x16_f16 v[36:51], v[8:11], v[92:95], v[36:51]
    s_nop 15
    s_nop 3
    v_mul_f32 v36, v36, v134
    v_max_f32 v132, v132, v36
    v_mul_f32 v37, v37, v134
    v_max_f32 v132, v132, v37
    v_mul_f32 v38, v38, v134
    v_max_f32 v132, v132, v38
    v_mul_f32 v39, v39, v134
    v_max_f32 v132, v132, v39
    v_mul_f32 v40, v40, v134
    v_max_f32 v132, v132, v40
    v_mul_f32 v41, v41, v134
    v_max_f32 v132, v132, v41
    v_mul_f32 v42, v42, v134
    v_max_f32 v132, v132, v42
    v_mul_f32 v43, v43, v134
    v_max_f32 v132, v132, v43
    v_mul_f32 v44, v44, v134
    v_max_f32 v132, v132, v44
    v_mul_f32 v45, v45, v134
    v_max_f32 v132, v132, v45
    v_mul_f32 v46, v46, v134
    v_max_f32 v132, v132, v46
    v_mul_f32 v47, v47, v134
    v_max_f32 v132, v132, v47
    v_mul_f32 v48, v48, v134
    v_max_f32 v132, v132, v48
    v_mul_f32 v49, v49, v134
    v_max_f32 v132, v132, v49
    v_mul_f32 v50, v50, v134
    v_max_f32 v132, v132, v50
    v_mul_f32 v51, v51, v134
    v_max_f32 v132, v132, v51
    s_nop 7
    v_mfma_f32_32x32x16_f16 v[36:51], v[4:7], v[88:91], 0
    v_mfma_f32_32x32x16_f16 v[36:51], v[8:11], v[96:99], v[36:51]
    s_nop 15
    s_nop 3
    v_mul_f32 v36, v36, v134
    v_max_f32 v133, v133, v36
    v_mul_f32 v37, v37, v134
    v_max_f32 v133, v133, v37
    v_mul_f32 v38, v38, v134
    v_max_f32 v133, v133, v38
    v_mul_f32 v39, v39, v134
    v_max_f32 v133, v133, v39
    v_mul_f32 v40, v40, v134
    v_max_f32 v133, v133, v40
    v_mul_f32 v41, v41, v134
    v_max_f32 v133, v133, v41
    v_mul_f32 v42, v42, v134
    v_max_f32 v133, v133, v42
    v_mul_f32 v43, v43, v134
    v_max_f32 v133, v133, v43
    v_mul_f32 v44, v44, v134
    v_max_f32 v133, v133, v44
    v_mul_f32 v45, v45, v134
    v_max_f32 v133, v133, v45
    v_mul_f32 v46, v46, v134
    v_max_f32 v133, v133, v46
    v_mul_f32 v47, v47, v134
    v_max_f32 v133, v133, v47
    v_mul_f32 v48, v48, v134
    v_max_f32 v133, v133, v48
    v_mul_f32 v49, v49, v134
    v_max_f32 v133, v133, v49
    v_mul_f32 v50, v50, v134
    v_max_f32 v133, v133, v50
    v_mul_f32 v51, v51, v134
    v_max_f32 v133, v133, v51
    s_nop 7
    ds_read_b128 v[4:7], v1 offset:14336
    ds_read_b128 v[8:11], v1 offset:15360
    s_waitcnt lgkmcnt(0)
    v_mfma_f32_32x32x16_f16 v[36:51], v[4:7], v[84:87], 0
    v_mfma_f32_32x32x16_f16 v[36:51], v[8:11], v[92:95], v[36:51]
    s_nop 15
    s_nop 3
    v_mul_f32 v36, v36, v134
    v_max_f32 v132, v132, v36
    v_mul_f32 v37, v37, v134
    v_max_f32 v132, v132, v37
    v_mul_f32 v38, v38, v134
    v_max_f32 v132, v132, v38
    v_mul_f32 v39, v39, v134
    v_max_f32 v132, v132, v39
    v_mul_f32 v40, v40, v134
    v_max_f32 v132, v132, v40
    v_mul_f32 v41, v41, v134
    v_max_f32 v132, v132, v41
    v_mul_f32 v42, v42, v134
    v_max_f32 v132, v132, v42
    v_mul_f32 v43, v43, v134
    v_max_f32 v132, v132, v43
    v_mul_f32 v44, v44, v134
    v_max_f32 v132, v132, v44
    v_mul_f32 v45, v45, v134
    v_max_f32 v132, v132, v45
    v_mul_f32 v46, v46, v134
    v_max_f32 v132, v132, v46
    v_mul_f32 v47, v47, v134
    v_max_f32 v132, v132, v47
    v_mul_f32 v48, v48, v134
    v_max_f32 v132, v132, v48
    v_mul_f32 v49, v49, v134
    v_max_f32 v132, v132, v49
    v_mul_f32 v50, v50, v134
    v_max_f32 v132, v132, v50
    v_mul_f32 v51, v51, v134
    v_max_f32 v132, v132, v51
    s_nop 7
    v_mfma_f32_32x32x16_f16 v[36:51], v[4:7], v[88:91], 0
    v_mfma_f32_32x32x16_f16 v[36:51], v[8:11], v[96:99], v[36:51]
    s_nop 15
    s_nop 3
    v_mul_f32 v36, v36, v134
    v_max_f32 v133, v133, v36
    v_mul_f32 v37, v37, v134
    v_max_f32 v133, v133, v37
    v_mul_f32 v38, v38, v134
    v_max_f32 v133, v133, v38
    v_mul_f32 v39, v39, v134
    v_max_f32 v133, v133, v39
    v_mul_f32 v40, v40, v134
    v_max_f32 v133, v133, v40
    v_mul_f32 v41, v41, v134
    v_max_f32 v133, v133, v41
    v_mul_f32 v42, v42, v134
    v_max_f32 v133, v133, v42
    v_mul_f32 v43, v43, v134
    v_max_f32 v133, v133, v43
    v_mul_f32 v44, v44, v134
    v_max_f32 v133, v133, v44
    v_mul_f32 v45, v45, v134
    v_max_f32 v133, v133, v45
    v_mul_f32 v46, v46, v134
    v_max_f32 v133, v133, v46
    v_mul_f32 v47, v47, v134
    v_max_f32 v133, v133, v47
    v_mul_f32 v48, v48, v134
    v_max_f32 v133, v133, v48
    v_mul_f32 v49, v49, v134
    v_max_f32 v133, v133, v49
    v_mul_f32 v50, v50, v134
    v_max_f32 v133, v133, v50
    v_mul_f32 v51, v51, v134
    v_max_f32 v133, v133, v51
    s_nop 7
    v_add_u32 v1, 32768, v1
    v_and_b32 v1, 0x1ffff, v1
    s_sub_u32 s33, s33, 1
    s_cmp_lg_u32 s33, 0
    s_cbranch_scc1 L_max_chunk
    v_mov_b32 v149, v132
    v_mov_b32 v138, v132
    s_nop 1
    v_permlane32_swap_b32 v149, v138
    s_nop 1
    v_max_f32 v132, v149, v138
    v_mov_b32 v149, v133
    v_mov_b32 v138, v133
    s_nop 1
    v_permlane32_swap_b32 v149, v138
    s_nop 1
    v_max_f32 v133, v149, v138
    v_mov_b32 v76, 0
    v_mov_b32 v28, 0
    v_mov_b32 v77, 0
    v_mov_b32 v29, 0
    v_mov_b32 v78, 0
    v_mov_b32 v30, 0
    v_mov_b32 v79, 0
    v_mov_b32 v31, 0
    v_mov_b32 v80, 0
    v_mov_b32 v32, 0
    v_mov_b32 v81, 0
    v_mov_b32 v33, 0
    v_mov_b32 v82, 0
    v_mov_b32 v34, 0
    v_mov_b32 v83, 0
    v_mov_b32 v35, 0
    v_mov_b32 v66, 0
    v_mov_b32 v67, 0
    s_barrier
    ds_read_b128 v[4:7], v1 offset:0
    ds_read_b128 v[8:11], v1 offset:1024
    ds_read_b128 v[20:23], v1 offset:16384
    ds_read_b128 v[24:27], v1 offset:17408
    ds_read_b128 v[12:15], v1 offset:2048
    ds_read_b128 v[16:19], v1 offset:3072
    s_waitcnt lgkmcnt(4)
    v_mfma_f32_32x32x16_f16 v[36:51], v[4:7], v[84:87], 0
    v_mfma_f32_32x32x16_f16 v[36:51], v[8:11], v[92:95], v[36:51]
    s_nop 15
    s_mov_b32 s33, 4
    s_mov_b32 s35, 0
    s_mov_b32 s48, 0x1c
L_main_s:
    v_mfma_f32_32x32x16_bf16 v[116:131], v[28:31], v[76:79], v[116:131]
    v_mul_f32 v36, v36, v134
    v_sub_f32 v36, v36, v132
    v_exp_f32 v36, v36
    v_mul_f32 v37, v37, v134
    v_sub_f32 v37, v37, v132
    v_exp_f32 v37, v37
    v_cvt_pk_bf16_f32 v83, v66, v67
    v_mul_f32 v38, v38, v134
    v_sub_f32 v38, v38, v132
    v_exp_f32 v38, v38
    v_mul_f32 v39, v39, v134
    v_sub_f32 v39, v39, v132
    v_exp_f32 v39, v39
    v_cvt_pk_bf16_f32 v68, v36, v37
    v_mfma_f32_32x32x16_f16 v[52:67], v[4:7], v[88:91], 0
    v_mul_f32 v40, v40, v134
    v_sub_f32 v40, v40, v132
    v_exp_f32 v40, v40
    v_mul_f32 v41, v41, v134
    v_sub_f32 v41, v41, v132
    v_exp_f32 v41, v41
    v_cvt_pk_bf16_f32 v69, v38, v39
    v_mul_f32 v42, v42, v134
    v_sub_f32 v42, v42, v132
    v_exp_f32 v42, v42
    v_mul_f32 v43, v43, v134
    v_sub_f32 v43, v43, v132
    v_exp_f32 v43, v43
    v_cvt_pk_bf16_f32 v70, v40, v41
    v_mfma_f32_32x32x16_f16 v[52:67], v[8:11], v[96:99], v[52:67]
    v_mul_f32 v44, v44, v134
    v_sub_f32 v44, v44, v132
    v_exp_f32 v44, v44
    v_mul_f32 v45, v45, v134
    v_sub_f32 v45, v45, v132
    v_exp_f32 v45, v45
    v_cvt_pk_bf16_f32 v71, v42, v43
    v_mul_f32 v46, v46, v134
    v_sub_f32 v46, v46, v132
    v_exp_f32 v46, v46
    v_mul_f32 v47, v47, v134
    v_sub_f32 v47, v47, v132
    v_exp_f32 v47, v47
    v_cvt_pk_bf16_f32 v72, v44, v45
    v_mfma_f32_32x32x16_bf16 v[116:131], v[32:35], v[80:83], v[116:131]
    s_waitcnt lgkmcnt(0)
    v_mul_f32 v48, v48, v134
    v_sub_f32 v48, v48, v132
    v_exp_f32 v48, v48
    v_mul_f32 v49, v49, v134
    v_sub_f32 v49, v49, v132
    v_exp_f32 v49, v49
    v_cvt_pk_bf16_f32 v73, v46, v47
    v_mul_f32 v50, v50, v134
    v_sub_f32 v50, v50, v132
    v_exp_f32 v50, v50
    v_mul_f32 v51, v51, v134
    v_sub_f32 v51, v51, v132
    v_exp_f32 v51, v51
    v_cvt_pk_bf16_f32 v74, v48, v49
    v_mfma_f32_32x32x16_bf16 v[100:115], v[20:23], v[68:71], v[100:115]
    ds_read_b128 v[28:31], v1 offset:18432
    v_mul_f32 v52, v52, v134
    v_sub_f32 v52, v52, v133
    v_exp_f32 v52, v52
    v_mul_f32 v53, v53, v134
    v_sub_f32 v53, v53, v133
    v_exp_f32 v53, v53
    v_cvt_pk_bf16_f32 v75, v50, v51
    v_mul_f32 v54, v54, v134
    v_sub_f32 v54, v54, v133
    v_exp_f32 v54, v54
    v_mul_f32 v55, v55, v134
    v_sub_f32 v55, v55, v133
    v_exp_f32 v55, v55
    v_cvt_pk_bf16_f32 v76, v52, v53
    v_mfma_f32_32x32x16_f16 v[36:51], v[12:15], v[84:87], 0
    ds_read_b128 v[32:35], v1 offset:19456
    v_mul_f32 v56, v56, v134
    v_sub_f32 v56, v56, v133
    v_exp_f32 v56, v56
    v_mul_f32 v57, v57, v134
    v_sub_f32 v57, v57, v133
    v_exp_f32 v57, v57
    v_cvt_pk_bf16_f32 v77, v54, v55
    v_mul_f32 v58, v58, v134
    v_sub_f32 v58, v58, v133
    v_exp_f32 v58, v58
    v_mul_f32 v59, v59, v134
    v_sub_f32 v59, v59, v133
    v_exp_f32 v59, v59
    v_cvt_pk_bf16_f32 v78, v56, v57
    v_mfma_f32_32x32x16_f16 v[36:51], v[16:19], v[92:95], v[36:51]
    ds_read_b128 v[4:7], v1 offset:4096
    v_mul_f32 v60, v60, v134
    v_sub_f32 v60, v60, v133
    v_exp_f32 v60, v60
    v_mul_f32 v61, v61, v134
    v_sub_f32 v61, v61, v133
    v_exp_f32 v61, v61
    v_cvt_pk_bf16_f32 v79, v58, v59
    v_mul_f32 v62, v62, v134
    v_sub_f32 v62, v62, v133
    v_exp_f32 v62, v62
    v_mul_f32 v63, v63, v134
    v_sub_f32 v63, v63, v133
    v_exp_f32 v63, v63
    v_cvt_pk_bf16_f32 v80, v60, v61
    v_mfma_f32_32x32x16_bf16 v[100:115], v[24:27], v[72:75], v[100:115]
    ds_read_b128 v[8:11], v1 offset:5120
    v_mul_f32 v64, v64, v134
    v_sub_f32 v64, v64, v133
    v_exp_f32 v64, v64
    v_mul_f32 v65, v65, v134
    v_sub_f32 v65, v65, v133
    v_exp_f32 v65, v65
    v_cvt_pk_bf16_f32 v81, v62, v63
    v_mul_f32 v66, v66, v134
    v_sub_f32 v66, v66, v133
    v_exp_f32 v66, v66
    v_mul_f32 v67, v67, v134
    v_sub_f32 v67, v67, v133
    v_exp_f32 v67, v67
    v_cvt_pk_bf16_f32 v82, v64, v65
    v_mfma_f32_32x32x16_bf16 v[116:131], v[20:23], v[76:79], v[116:131]
    v_mul_f32 v36, v36, v134
    v_sub_f32 v36, v36, v132
    v_exp_f32 v36, v36
    v_mul_f32 v37, v37, v134
    v_sub_f32 v37, v37, v132
    v_exp_f32 v37, v37
    v_cvt_pk_bf16_f32 v83, v66, v67
    v_mul_f32 v38, v38, v134
    v_sub_f32 v38, v38, v132
    v_exp_f32 v38, v38
    v_mul_f32 v39, v39, v134
    v_sub_f32 v39, v39, v132
    v_exp_f32 v39, v39
    v_cvt_pk_bf16_f32 v68, v36, v37
    v_mfma_f32_32x32x16_f16 v[52:67], v[12:15], v[88:91], 0
    v_mul_f32 v40, v40, v134
    v_sub_f32 v40, v40, v132
    v_exp_f32 v40, v40
    v_mul_f32 v41, v41, v134
    v_sub_f32 v41, v41, v132
    v_exp_f32 v41, v41
    v_cvt_pk_bf16_f32 v69, v38, v39
    v_mul_f32 v42, v42, v134
    v_sub_f32 v42, v42, v132
    v_exp_f32 v42, v42
    v_mul_f32 v43, v43, v134
    v_sub_f32 v43, v43, v132
    v_exp_f32 v43, v43
    v_cvt_pk_bf16_f32 v70, v40, v41
    v_mfma_f32_32x32x16_f16 v[52:67], v[16:19], v[96:99], v[52:67]
    v_mul_f32 v44, v44, v134
    v_sub_f32 v44, v44, v132
    v_exp_f32 v44, v44
    v_mul_f32 v45, v45, v134
    v_sub_f32 v45, v45, v132
    v_exp_f32 v45, v45
    v_cvt_pk_bf16_f32 v71, v42, v43
    v_mul_f32 v46, v46, v134
    v_sub_f32 v46, v46, v132
    v_exp_f32 v46, v46
    v_mul_f32 v47, v47, v134
    v_sub_f32 v47, v47, v132
    v_exp_f32 v47, v47
    v_cvt_pk_bf16_f32 v72, v44, v45
    v_mfma_f32_32x32x16_bf16 v[116:131], v[24:27], v[80:83], v[116:131]
    s_waitcnt lgkmcnt(0)
    v_mul_f32 v48, v48, v134
    v_sub_f32 v48, v48, v132
    v_exp_f32 v48, v48
    v_mul_f32 v49, v49, v134
    v_sub_f32 v49, v49, v132
    v_exp_f32 v49, v49
    v_cvt_pk_bf16_f32 v73, v46, v47
    v_mul_f32 v50, v50, v134
    v_sub_f32 v50, v50, v132
    v_exp_f32 v50, v50
    v_mul_f32 v51, v51, v134
    v_sub_f32 v51, v51, v132
    v_exp_f32 v51, v51
    v_cvt_pk_bf16_f32 v74, v48, v49
    v_mfma_f32_32x32x16_bf16 v[100:115], v[28:31], v[68:71], v[100:115]
    ds_read_b128 v[20:23], v1 offset:20480
    v_mul_f32 v52, v52, v134
    v_sub_f32 v52, v52, v133
    v_exp_f32 v52, v52
    v_mul_f32 v53, v53, v134
    v_sub_f32 v53, v53, v133
    v_exp_f32 v53, v53
    v_cvt_pk_bf16_f32 v75, v50, v51
    v_mul_f32 v54, v54, v134
    v_sub_f32 v54, v54, v133
    v_exp_f32 v54, v54
    v_mul_f32 v55, v55, v134
    v_sub_f32 v55, v55, v133
    v_exp_f32 v55, v55
    v_cvt_pk_bf16_f32 v76, v52, v53
    v_mfma_f32_32x32x16_f16 v[36:51], v[4:7], v[84:87], 0
    ds_read_b128 v[24:27], v1 offset:21504
    v_mul_f32 v56, v56, v134
    v_sub_f32 v56, v56, v133
    v_exp_f32 v56, v56
    v_mul_f32 v57, v57, v134
    v_sub_f32 v57, v57, v133
    v_exp_f32 v57, v57
    v_cvt_pk_bf16_f32 v77, v54, v55
    v_mul_f32 v58, v58, v134
    v_sub_f32 v58, v58, v133
    v_exp_f32 v58, v58
    v_mul_f32 v59, v59, v134
    v_sub_f32 v59, v59, v133
    v_exp_f32 v59, v59
    v_cvt_pk_bf16_f32 v78, v56, v57
    v_mfma_f32_32x32x16_f16 v[36:51], v[8:11], v[92:95], v[36:51]
    ds_read_b128 v[12:15], v1 offset:6144
    v_mul_f32 v60, v60, v134
    v_sub_f32 v60, v60, v133
    v_exp_f32 v60, v60
    v_mul_f32 v61, v61, v134
    v_sub_f32 v61, v61, v133
    v_exp_f32 v61, v61
    v_cvt_pk_bf16_f32 v79, v58, v59
    v_mul_f32 v62, v62, v134
    v_sub_f32 v62, v62, v133
    v_exp_f32 v62, v62
    v_mul_f32 v63, v63, v134
    v_sub_f32 v63, v63, v133
    v_exp_f32 v63, v63
    v_cvt_pk_bf16_f32 v80, v60, v61
    v_mfma_f32_32x32x16_bf16 v[100:115], v[32:35], v[72:75], v[100:115]
    ds_read_b128 v[16:19], v1 offset:7168
    v_mul_f32 v64, v64, v134
    v_sub_f32 v64, v64, v133
    v_exp_f32 v64, v64
    v_mul_f32 v65, v65, v134
    v_sub_f32 v65, v65, v133
    v_exp_f32 v65, v65
    v_cvt_pk_bf16_f32 v81, v62, v63
    v_mul_f32 v66, v66, v134
    v_sub_f32 v66, v66, v133
    v_exp_f32 v66, v66
    v_mul_f32 v67, v67, v134
    v_sub_f32 v67, v67, v133
    v_exp_f32 v67, v67
    v_cvt_pk_bf16_f32 v82, v64, v65
    v_mfma_f32_32x32x16_bf16 v[116:131], v[28:31], v[76:79], v[116:131]
    v_mul_f32 v36, v36, v134
    v_sub_f32 v36, v36, v132
    v_exp_f32 v36, v36
    v_mul_f32 v37, v37, v134
    v_sub_f32 v37, v37, v132
    v_exp_f32 v37, v37
    v_cvt_pk_bf16_f32 v83, v66, v67
    v_mul_f32 v38, v38, v134
    v_sub_f32 v38, v38, v132
    v_exp_f32 v38, v38
    v_mul_f32 v39, v39, v134
    v_sub_f32 v39, v39, v132
    v_exp_f32 v39, v39
    v_cvt_pk_bf16_f32 v68, v36, v37
    v_mfma_f32_32x32x16_f16 v[52:67], v[4:7], v[88:91], 0
    v_mul_f32 v40, v40, v134
    v_sub_f32 v40, v40, v132
    v_exp_f32 v40, v40
    v_mul_f32 v41, v41, v134
    v_sub_f32 v41, v41, v132
    v_exp_f32 v41, v41
    v_cvt_pk_bf16_f32 v69, v38, v39
    v_mul_f32 v42, v42, v134
    v_sub_f32 v42, v42, v132
    v_exp_f32 v42, v42
    v_mul_f32 v43, v43, v134
    v_sub_f32 v43, v43, v132
    v_exp_f32 v43, v43
    v_cvt_pk_bf16_f32 v70, v40, v41
    v_mfma_f32_32x32x16_f16 v[52:67], v[8:11], v[96:99], v[52:67]
    v_mul_f32 v44, v44, v134
    v_sub_f32 v44, v44, v132
    v_exp_f32 v44, v44
    v_mul_f32 v45, v45, v134
    v_sub_f32 v45, v45, v132
    v_exp_f32 v45, v45
    v_cvt_pk_bf16_f32 v71, v42, v43
    v_mul_f32 v46, v46, v134
    v_sub_f32 v46, v46, v132
    v_exp_f32 v46, v46
    v_mul_f32 v47, v47, v134
    v_sub_f32 v47, v47, v132
    v_exp_f32 v47, v47
    v_cvt_pk_bf16_f32 v72, v44, v45
    v_mfma_f32_32x32x16_bf16 v[116:131], v[32:35], v[80:83], v[116:131]
    s_waitcnt lgkmcnt(0)
    v_mul_f32 v48, v48, v134
    v_sub_f32 v48, v48, v132
    v_exp_f32 v48, v48
    v_mul_f32 v49, v49, v134
    v_sub_f32 v49, v49, v132
    v_exp_f32 v49, v49
    v_cvt_pk_bf16_f32 v73, v46, v47
    v_mul_f32 v50, v50, v134
    v_sub_f32 v50, v50, v132
    v_exp_f32 v50, v50
    v_mul_f32 v51, v51, v134
    v_sub_f32 v51, v51, v132
    v_exp_f32 v51, v51
    v_cvt_pk_bf16_f32 v74, v48, v49
    v_mfma_f32_32x32x16_bf16 v[100:115], v[20:23], v[68:71], v[100:115]
    ds_read_b128 v[28:31], v1 offset:22528
    v_mul_f32 v52, v52, v134
    v_sub_f32 v52, v52, v133
    v_exp_f32 v52, v52
    v_mul_f32 v53, v53, v134
    v_sub_f32 v53, v53, v133
    v_exp_f32 v53, v53
    v_cvt_pk_bf16_f32 v75, v50, v51
    v_mul_f32 v54, v54, v134
    v_sub_f32 v54, v54, v133
    v_exp_f32 v54, v54
    v_mul_f32 v55, v55, v134
    v_sub_f32 v55, v55, v133
    v_exp_f32 v55, v55
    v_cvt_pk_bf16_f32 v76, v52, v53
    v_mfma_f32_32x32x16_f16 v[36:51], v[12:15], v[84:87], 0
    ds_read_b128 v[32:35], v1 offset:23552
    v_mul_f32 v56, v56, v134
    v_sub_f32 v56, v56, v133
    v_exp_f32 v56, v56
    v_mul_f32 v57, v57, v134
    v_sub_f32 v57, v57, v133
    v_exp_f32 v57, v57
    v_cvt_pk_bf16_f32 v77, v54, v55
    v_mul_f32 v58, v58, v134
    v_sub_f32 v58, v58, v133
    v_exp_f32 v58, v58
    v_mul_f32 v59, v59, v134
    v_sub_f32 v59, v59, v133
    v_exp_f32 v59, v59
    v_cvt_pk_bf16_f32 v78, v56, v57
    v_mfma_f32_32x32x16_f16 v[36:51], v[16:19], v[92:95], v[36:51]
    ds_read_b128 v[4:7], v1 offset:8192
    v_mul_f32 v60, v60, v134
    v_sub_f32 v60, v60, v133
    v_exp_f32 v60, v60
    v_mul_f32 v61, v61, v134
    v_sub_f32 v61, v61, v133
    v_exp_f32 v61, v61
    v_cvt_pk_bf16_f32 v79, v58, v59
    v_mul_f32 v62, v62, v134
    v_sub_f32 v62, v62, v133
    v_exp_f32 v62, v62
    v_mul_f32 v63, v63, v134
    v_sub_f32 v63, v63, v133
    v_exp_f32 v63, v63
    v_cvt_pk_bf16_f32 v80, v60, v61
    v_mfma_f32_32x32x16_bf16 v[100:115], v[24:27], v[72:75], v[100:115]
    ds_read_b128 v[8:11], v1 offset:9216
    v_mul_f32 v64, v64, v134
    v_sub_f32 v64, v64, v133
    v_exp_f32 v64, v64
    v_mul_f32 v65, v65, v134
    v_sub_f32 v65, v65, v133
    v_exp_f32 v65, v65
    v_cvt_pk_bf16_f32 v81, v62, v63
    v_mul_f32 v66, v66, v134
    v_sub_f32 v66, v66, v133
    v_exp_f32 v66, v66
    v_mul_f32 v67, v67, v134
    v_sub_f32 v67, v67, v133
    v_exp_f32 v67, v67
    v_cvt_pk_bf16_f32 v82, v64, v65
    v_mfma_f32_32x32x16_bf16 v[116:131], v[20:23], v[76:79], v[116:131]
    v_mul_f32 v36, v36, v134
    v_sub_f32 v36, v36, v132
    v_exp_f32 v36, v36
    v_mul_f32 v37, v37, v134
    v_sub_f32 v37, v37, v132
    v_exp_f32 v37, v37
    v_cvt_pk_bf16_f32 v83, v66, v67
    v_mul_f32 v38, v38, v134
    v_sub_f32 v38, v38, v132
    v_exp_f32 v38, v38
    v_mul_f32 v39, v39, v134
    v_sub_f32 v39, v39, v132
    v_exp_f32 v39, v39
    v_cvt_pk_bf16_f32 v68, v36, v37
    v_mfma_f32_32x32x16_f16 v[52:67], v[12:15], v[88:91], 0
    v_mul_f32 v40, v40, v134
    v_sub_f32 v40, v40, v132
    v_exp_f32 v40, v40
    v_mul_f32 v41, v41, v134
    v_sub_f32 v41, v41, v132
    v_exp_f32 v41, v41
    v_cvt_pk_bf16_f32 v69, v38, v39
    v_mul_f32 v42, v42, v134
    v_sub_f32 v42, v42, v132
    v_exp_f32 v42, v42
    v_mul_f32 v43, v43, v134
    v_sub_f32 v43, v43, v132
    v_exp_f32 v43, v43
    v_cvt_pk_bf16_f32 v70, v40, v41
    v_mfma_f32_32x32x16_f16 v[52:67], v[16:19], v[96:99], v[52:67]
    v_mul_f32 v44, v44, v134
    v_sub_f32 v44, v44, v132
    v_exp_f32 v44, v44
    v_mul_f32 v45, v45, v134
    v_sub_f32 v45, v45, v132
    v_exp_f32 v45, v45
    v_cvt_pk_bf16_f32 v71, v42, v43
    v_mul_f32 v46, v46, v134
    v_sub_f32 v46, v46, v132
    v_exp_f32 v46, v46
    v_mul_f32 v47, v47, v134
    v_sub_f32 v47, v47, v132
    v_exp_f32 v47, v47
    v_cvt_pk_bf16_f32 v72, v44, v45
    v_mfma_f32_32x32x16_bf16 v[116:131], v[24:27], v[80:83], v[116:131]
    s_waitcnt lgkmcnt(0)
    v_mul_f32 v48, v48, v134
    v_sub_f32 v48, v48, v132
    v_exp_f32 v48, v48
    v_mul_f32 v49, v49, v134
    v_sub_f32 v49, v49, v132
    v_exp_f32 v49, v49
    v_cvt_pk_bf16_f32 v73, v46, v47
    v_mul_f32 v50, v50, v134
    v_sub_f32 v50, v50, v132
    v_exp_f32 v50, v50
    v_mul_f32 v51, v51, v134
    v_sub_f32 v51, v51, v132
    v_exp_f32 v51, v51
    v_cvt_pk_bf16_f32 v74, v48, v49
    v_mfma_f32_32x32x16_bf16 v[100:115], v[28:31], v[68:71], v[100:115]
    ds_read_b128 v[20:23], v1 offset:24576
    v_mul_f32 v52, v52, v134
    v_sub_f32 v52, v52, v133
    v_exp_f32 v52, v52
    v_mul_f32 v53, v53, v134
    v_sub_f32 v53, v53, v133
    v_exp_f32 v53, v53
    v_cvt_pk_bf16_f32 v75, v50, v51
    v_mul_f32 v54, v54, v134
    v_sub_f32 v54, v54, v133
    v_exp_f32 v54, v54
    v_mul_f32 v55, v55, v134
    v_sub_f32 v55, v55, v133
    v_exp_f32 v55, v55
    v_cvt_pk_bf16_f32 v76, v52, v53
    v_mfma_f32_32x32x16_f16 v[36:51], v[4:7], v[84:87], 0
    ds_read_b128 v[24:27], v1 offset:25600
    v_mul_f32 v56, v56, v134
    v_sub_f32 v56, v56, v133
    v_exp_f32 v56, v56
    v_mul_f32 v57, v57, v134
    v_sub_f32 v57, v57, v133
    v_exp_f32 v57, v57
    v_cvt_pk_bf16_f32 v77, v54, v55
    v_mul_f32 v58, v58, v134
    v_sub_f32 v58, v58, v133
    v_exp_f32 v58, v58
    v_mul_f32 v59, v59, v134
    v_sub_f32 v59, v59, v133
    v_exp_f32 v59, v59
    v_cvt_pk_bf16_f32 v78, v56, v57
    v_mfma_f32_32x32x16_f16 v[36:51], v[8:11], v[92:95], v[36:51]
    ds_read_b128 v[12:15], v1 offset:10240
    v_mul_f32 v60, v60, v134
    v_sub_f32 v60, v60, v133
    v_exp_f32 v60, v60
    v_mul_f32 v61, v61, v134
    v_sub_f32 v61, v61, v133
    v_exp_f32 v61, v61
    v_cvt_pk_bf16_f32 v79, v58, v59
    v_mul_f32 v62, v62, v134
    v_sub_f32 v62, v62, v133
    v_exp_f32 v62, v62
    v_mul_f32 v63, v63, v134
    v_sub_f32 v63, v63, v133
    v_exp_f32 v63, v63
    v_cvt_pk_bf16_f32 v80, v60, v61
    v_mfma_f32_32x32x16_bf16 v[100:115], v[32:35], v[72:75], v[100:115]
    ds_read_b128 v[16:19], v1 offset:11264
    v_mul_f32 v64, v64, v134
    v_sub_f32 v64, v64, v133
    v_exp_f32 v64, v64
    v_mul_f32 v65, v65, v134
    v_sub_f32 v65, v65, v133
    v_exp_f32 v65, v65
    v_cvt_pk_bf16_f32 v81, v62, v63
    v_mul_f32 v66, v66, v134
    v_sub_f32 v66, v66, v133
    v_exp_f32 v66, v66
    v_mul_f32 v67, v67, v134
    v_sub_f32 v67, v67, v133
    v_exp_f32 v67, v67
    v_cvt_pk_bf16_f32 v82, v64, v65
    v_mfma_f32_32x32x16_bf16 v[116:131], v[28:31], v[76:79], v[116:131]
    v_mul_f32 v36, v36, v134
    v_sub_f32 v36, v36, v132
    v_exp_f32 v36, v36
    v_mul_f32 v37, v37, v134
    v_sub_f32 v37, v37, v132
    v_exp_f32 v37, v37
    v_cvt_pk_bf16_f32 v83, v66, v67
    v_mul_f32 v38, v38, v134
    v_sub_f32 v38, v38, v132
    v_exp_f32 v38, v38
    v_mul_f32 v39, v39, v134
    v_sub_f32 v39, v39, v132
    v_exp_f32 v39, v39
    v_cvt_pk_bf16_f32 v68, v36, v37
    v_mfma_f32_32x32x16_f16 v[52:67], v[4:7], v[88:91], 0
    v_mul_f32 v40, v40, v134
    v_sub_f32 v40, v40, v132
    v_exp_f32 v40, v40
    v_mul_f32 v41, v41, v134
    v_sub_f32 v41, v41, v132
    v_exp_f32 v41, v41
    v_cvt_pk_bf16_f32 v69, v38, v39
    v_mul_f32 v42, v42, v134
    v_sub_f32 v42, v42, v132
    v_exp_f32 v42, v42
    v_mul_f32 v43, v43, v134
    v_sub_f32 v43, v43, v132
    v_exp_f32 v43, v43
    v_cvt_pk_bf16_f32 v70, v40, v41
    v_mfma_f32_32x32x16_f16 v[52:67], v[8:11], v[96:99], v[52:67]
    v_mul_f32 v44, v44, v134
    v_sub_f32 v44, v44, v132
    v_exp_f32 v44, v44
    v_mul_f32 v45, v45, v134
    v_sub_f32 v45, v45, v132
    v_exp_f32 v45, v45
    v_cvt_pk_bf16_f32 v71, v42, v43
    v_mul_f32 v46, v46, v134
    v_sub_f32 v46, v46, v132
    v_exp_f32 v46, v46
    v_mul_f32 v47, v47, v134
    v_sub_f32 v47, v47, v132
    v_exp_f32 v47, v47
    v_cvt_pk_bf16_f32 v72, v44, v45
    v_mfma_f32_32x32x16_bf16 v[116:131], v[32:35], v[80:83], v[116:131]
    s_waitcnt lgkmcnt(0)
    v_mul_f32 v48, v48, v134
    v_sub_f32 v48, v48, v132
    v_exp_f32 v48, v48
    v_mul_f32 v49, v49, v134
    v_sub_f32 v49, v49, v132
    v_exp_f32 v49, v49
    v_cvt_pk_bf16_f32 v73, v46, v47
    v_mul_f32 v50, v50, v134
    v_sub_f32 v50, v50, v132
    v_exp_f32 v50, v50
    v_mul_f32 v51, v51, v134
    v_sub_f32 v51, v51, v132
    v_exp_f32 v51, v51
    v_cvt_pk_bf16_f32 v74, v48, v49
    v_mfma_f32_32x32x16_bf16 v[100:115], v[20:23], v[68:71], v[100:115]
    ds_read_b128 v[28:31], v1 offset:26624
    v_mul_f32 v52, v52, v134
    v_sub_f32 v52, v52, v133
    v_exp_f32 v52, v52
    v_mul_f32 v53, v53, v134
    v_sub_f32 v53, v53, v133
    v_exp_f32 v53, v53
    v_cvt_pk_bf16_f32 v75, v50, v51
    v_mul_f32 v54, v54, v134
    v_sub_f32 v54, v54, v133
    v_exp_f32 v54, v54
    v_mul_f32 v55, v55, v134
    v_sub_f32 v55, v55, v133
    v_exp_f32 v55, v55
    v_cvt_pk_bf16_f32 v76, v52, v53
    v_mfma_f32_32x32x16_f16 v[36:51], v[12:15], v[84:87], 0
    ds_read_b128 v[32:35], v1 offset:27648
    v_mul_f32 v56, v56, v134
    v_sub_f32 v56, v56, v133
    v_exp_f32 v56, v56
    v_mul_f32 v57, v57, v134
    v_sub_f32 v57, v57, v133
    v_exp_f32 v57, v57
    v_cvt_pk_bf16_f32 v77, v54, v55
    v_mul_f32 v58, v58, v134
    v_sub_f32 v58, v58, v133
    v_exp_f32 v58, v58
    v_mul_f32 v59, v59, v134
    v_sub_f32 v59, v59, v133
    v_exp_f32 v59, v59
    v_cvt_pk_bf16_f32 v78, v56, v57
    v_mfma_f32_32x32x16_f16 v[36:51], v[16:19], v[92:95], v[36:51]
    ds_read_b128 v[4:7], v1 offset:12288
    v_mul_f32 v60, v60, v134
    v_sub_f32 v60, v60, v133
    v_exp_f32 v60, v60
    v_mul_f32 v61, v61, v134
    v_sub_f32 v61, v61, v133
    v_exp_f32 v61, v61
    v_cvt_pk_bf16_f32 v79, v58, v59
    v_mul_f32 v62, v62, v134
    v_sub_f32 v62, v62, v133
    v_exp_f32 v62, v62
    v_mul_f32 v63, v63, v134
    v_sub_f32 v63, v63, v133
    v_exp_f32 v63, v63
    v_cvt_pk_bf16_f32 v80, v60, v61
    v_mfma_f32_32x32x16_bf16 v[100:115], v[24:27], v[72:75], v[100:115]
    ds_read_b128 v[8:11], v1 offset:13312
    v_mul_f32 v64, v64, v134
    v_sub_f32 v64, v64, v133
    v_exp_f32 v64, v64
    v_mul_f32 v65, v65, v134
    v_sub_f32 v65, v65, v133
    v_exp_f32 v65, v65
    v_cvt_pk_bf16_f32 v81, v62, v63
    v_mul_f32 v66, v66, v134
    v_sub_f32 v66, v66, v133
    v_exp_f32 v66, v66
    v_mul_f32 v67, v67, v134
    v_sub_f32 v67, v67, v133
    v_exp_f32 v67, v67
    v_cvt_pk_bf16_f32 v82, v64, v65
    v_mfma_f32_32x32x16_bf16 v[116:131], v[20:23], v[76:79], v[116:131]
    v_mul_f32 v36, v36, v134
    v_sub_f32 v36, v36, v132
    v_exp_f32 v36, v36
    v_mul_f32 v37, v37, v134
    v_sub_f32 v37, v37, v132
    v_exp_f32 v37, v37
    v_cvt_pk_bf16_f32 v83, v66, v67
    v_mul_f32 v38, v38, v134
    v_sub_f32 v38, v38, v132
    v_exp_f32 v38, v38
    v_mul_f32 v39, v39, v134
    v_sub_f32 v39, v39, v132
    v_exp_f32 v39, v39
    v_cvt_pk_bf16_f32 v68, v36, v37
    v_mfma_f32_32x32x16_f16 v[52:67], v[12:15], v[88:91], 0
    v_mul_f32 v40, v40, v134
    v_sub_f32 v40, v40, v132
    v_exp_f32 v40, v40
    v_mul_f32 v41, v41, v134
    v_sub_f32 v41, v41, v132
    v_exp_f32 v41, v41
    v_cvt_pk_bf16_f32 v69, v38, v39
    v_mul_f32 v42, v42, v134
    v_sub_f32 v42, v42, v132
    v_exp_f32 v42, v42
    v_mul_f32 v43, v43, v134
    v_sub_f32 v43, v43, v132
    v_exp_f32 v43, v43
    v_cvt_pk_bf16_f32 v70, v40, v41
    v_mfma_f32_32x32x16_f16 v[52:67], v[16:19], v[96:99], v[52:67]
    v_mul_f32 v44, v44, v134
    v_sub_f32 v44, v44, v132
    v_exp_f32 v44, v44
    v_mul_f32 v45, v45, v134
    v_sub_f32 v45, v45, v132
    v_exp_f32 v45, v45
    v_cvt_pk_bf16_f32 v71, v42, v43
    v_mul_f32 v46, v46, v134
    v_sub_f32 v46, v46, v132
    v_exp_f32 v46, v46
    v_mul_f32 v47, v47, v134
    v_sub_f32 v47, v47, v132
    v_exp_f32 v47, v47
    v_cvt_pk_bf16_f32 v72, v44, v45
    v_mfma_f32_32x32x16_bf16 v[116:131], v[24:27], v[80:83], v[116:131]
    s_waitcnt lgkmcnt(0)
    v_mul_f32 v48, v48, v134
    v_sub_f32 v48, v48, v132
    v_exp_f32 v48, v48
    v_mul_f32 v49, v49, v134
    v_sub_f32 v49, v49, v132
    v_exp_f32 v49, v49
    v_cvt_pk_bf16_f32 v73, v46, v47
    v_mul_f32 v50, v50, v134
    v_sub_f32 v50, v50, v132
    v_exp_f32 v50, v50
    v_mul_f32 v51, v51, v134
    v_sub_f32 v51, v51, v132
    v_exp_f32 v51, v51
    v_cvt_pk_bf16_f32 v74, v48, v49
    v_mfma_f32_32x32x16_bf16 v[100:115], v[28:31], v[68:71], v[100:115]
    ds_read_b128 v[20:23], v1 offset:28672
    v_mul_f32 v52, v52, v134
    v_sub_f32 v52, v52, v133
    v_exp_f32 v52, v52
    v_mul_f32 v53, v53, v134
    v_sub_f32 v53, v53, v133
    v_exp_f32 v53, v53
    v_cvt_pk_bf16_f32 v75, v50, v51
    v_mul_f32 v54, v54, v134
    v_sub_f32 v54, v54, v133
    v_exp_f32 v54, v54
    v_mul_f32 v55, v55, v134
    v_sub_f32 v55, v55, v133
    v_exp_f32 v55, v55
    v_cvt_pk_bf16_f32 v76, v52, v53
    v_mfma_f32_32x32x16_f16 v[36:51], v[4:7], v[84:87], 0
    ds_read_b128 v[24:27], v1 offset:29696
    v_mul_f32 v56, v56, v134
    v_sub_f32 v56, v56, v133
    v_exp_f32 v56, v56
    v_mul_f32 v57, v57, v134
    v_sub_f32 v57, v57, v133
    v_exp_f32 v57, v57
    v_cvt_pk_bf16_f32 v77, v54, v55
    v_mul_f32 v58, v58, v134
    v_sub_f32 v58, v58, v133
    v_exp_f32 v58, v58
    v_mul_f32 v59, v59, v134
    v_sub_f32 v59, v59, v133
    v_exp_f32 v59, v59
    v_cvt_pk_bf16_f32 v78, v56, v57
    v_mfma_f32_32x32x16_f16 v[36:51], v[8:11], v[92:95], v[36:51]
    ds_read_b128 v[12:15], v1 offset:14336
    v_mul_f32 v60, v60, v134
    v_sub_f32 v60, v60, v133
    v_exp_f32 v60, v60
    v_mul_f32 v61, v61, v134
    v_sub_f32 v61, v61, v133
    v_exp_f32 v61, v61
    v_cvt_pk_bf16_f32 v79, v58, v59
    v_mul_f32 v62, v62, v134
    v_sub_f32 v62, v62, v133
    v_exp_f32 v62, v62
    v_mul_f32 v63, v63, v134
    v_sub_f32 v63, v63, v133
    v_exp_f32 v63, v63
    v_cvt_pk_bf16_f32 v80, v60, v61
    v_mfma_f32_32x32x16_bf16 v[100:115], v[32:35], v[72:75], v[100:115]
    ds_read_b128 v[16:19], v1 offset:15360
    v_mul_f32 v64, v64, v134
    v_sub_f32 v64, v64, v133
    v_exp_f32 v64, v64
    v_mul_f32 v65, v65, v134
    v_sub_f32 v65, v65, v133
    v_exp_f32 v65, v65
    v_cvt_pk_bf16_f32 v81, v62, v63
    v_mul_f32 v66, v66, v134
    v_sub_f32 v66, v66, v133
    v_exp_f32 v66, v66
    v_mul_f32 v67, v67, v134
    v_sub_f32 v67, v67, v133
    v_exp_f32 v67, v67
    v_cvt_pk_bf16_f32 v82, v64, v65
    v_mfma_f32_32x32x16_bf16 v[116:131], v[28:31], v[76:79], v[116:131]
    v_mul_f32 v36, v36, v134
    v_sub_f32 v36, v36, v132
    v_exp_f32 v36, v36
    v_mul_f32 v37, v37, v134
    v_sub_f32 v37, v37, v132
    v_exp_f32 v37, v37
    v_cvt_pk_bf16_f32 v83, v66, v67
    v_mul_f32 v38, v38, v134
    v_sub_f32 v38, v38, v132
    v_exp_f32 v38, v38
    v_mul_f32 v39, v39, v134
    v_sub_f32 v39, v39, v132
    v_exp_f32 v39, v39
    v_cvt_pk_bf16_f32 v68, v36, v37
    v_mfma_f32_32x32x16_f16 v[52:67], v[4:7], v[88:91], 0
    v_mul_f32 v40, v40, v134
    v_sub_f32 v40, v40, v132
    v_exp_f32 v40, v40
    v_mul_f32 v41, v41, v134
    v_sub_f32 v41, v41, v132
    v_exp_f32 v41, v41
    v_cvt_pk_bf16_f32 v69, v38, v39
    v_mul_f32 v42, v42, v134
    v_sub_f32 v42, v42, v132
    v_exp_f32 v42, v42
    v_mul_f32 v43, v43, v134
    v_sub_f32 v43, v43, v132
    v_exp_f32 v43, v43
    v_cvt_pk_bf16_f32 v70, v40, v41
    v_mfma_f32_32x32x16_f16 v[52:67], v[8:11], v[96:99], v[52:67]
    v_mul_f32 v44, v44, v134
    v_sub_f32 v44, v44, v132
    v_exp_f32 v44, v44
    v_mul_f32 v45, v45, v134
    v_sub_f32 v45, v45, v132
    v_exp_f32 v45, v45
    v_cvt_pk_bf16_f32 v71, v42, v43
    v_mul_f32 v46, v46, v134
    v_sub_f32 v46, v46, v132
    v_exp_f32 v46, v46
    v_mul_f32 v47, v47, v134
    v_sub_f32 v47, v47, v132
    v_exp_f32 v47, v47
    v_cvt_pk_bf16_f32 v72, v44, v45
    v_mfma_f32_32x32x16_bf16 v[116:131], v[32:35], v[80:83], v[116:131]
    s_waitcnt lgkmcnt(0)
    v_mul_f32 v48, v48, v134
    v_sub_f32 v48, v48, v132
    v_exp_f32 v48, v48
    v_mul_f32 v49, v49, v134
    v_sub_f32 v49, v49, v132
    v_exp_f32 v49, v49
    v_cvt_pk_bf16_f32 v73, v46, v47
    v_mul_f32 v50, v50, v134
    v_sub_f32 v50, v50, v132
    v_exp_f32 v50, v50
    v_mul_f32 v51, v51, v134
    v_sub_f32 v51, v51, v132
    v_exp_f32 v51, v51
    v_cvt_pk_bf16_f32 v74, v48, v49
    v_mfma_f32_32x32x16_bf16 v[100:115], v[20:23], v[68:71], v[100:115]
    ds_read_b128 v[28:31], v1 offset:30720
    v_mul_f32 v52, v52, v134
    v_sub_f32 v52, v52, v133
    v_exp_f32 v52, v52
    v_mul_f32 v53, v53, v134
    v_sub_f32 v53, v53, v133
    v_exp_f32 v53, v53
    v_cvt_pk_bf16_f32 v75, v50, v51
    v_mul_f32 v54, v54, v134
    v_sub_f32 v54, v54, v133
    v_exp_f32 v54, v54
    v_mul_f32 v55, v55, v134
    v_sub_f32 v55, v55, v133
    v_exp_f32 v55, v55
    v_cvt_pk_bf16_f32 v76, v52, v53
    v_mfma_f32_32x32x16_f16 v[36:51], v[12:15], v[84:87], 0
    ds_read_b128 v[32:35], v1 offset:31744
    v_mul_f32 v56, v56, v134
    v_sub_f32 v56, v56, v133
    v_exp_f32 v56, v56
    v_mul_f32 v57, v57, v134
    v_sub_f32 v57, v57, v133
    v_exp_f32 v57, v57
    v_cvt_pk_bf16_f32 v77, v54, v55
    v_mul_f32 v58, v58, v134
    v_sub_f32 v58, v58, v133
    v_exp_f32 v58, v58
    v_mul_f32 v59, v59, v134
    v_sub_f32 v59, v59, v133
    v_exp_f32 v59, v59
    v_cvt_pk_bf16_f32 v78, v56, v57
    v_mfma_f32_32x32x16_f16 v[36:51], v[16:19], v[92:95], v[36:51]
    v_mul_f32 v60, v60, v134
    v_sub_f32 v60, v60, v133
    v_exp_f32 v60, v60
    v_mul_f32 v61, v61, v134
    v_sub_f32 v61, v61, v133
    v_exp_f32 v61, v61
    v_cvt_pk_bf16_f32 v79, v58, v59
    v_mul_f32 v62, v62, v134
    v_sub_f32 v62, v62, v133
    v_exp_f32 v62, v62
    v_mul_f32 v63, v63, v134
    v_sub_f32 v63, v63, v133
    v_exp_f32 v63, v63
    v_cvt_pk_bf16_f32 v80, v60, v61
    v_mfma_f32_32x32x16_bf16 v[100:115], v[24:27], v[72:75], v[100:115]
    v_mul_f32 v64, v64, v134
    v_sub_f32 v64, v64, v133
    v_exp_f32 v64, v64
    v_mul_f32 v65, v65, v134
    v_sub_f32 v65, v65, v133
    v_exp_f32 v65, v65
    v_cvt_pk_bf16_f32 v81, v62, v63
    v_mul_f32 v66, v66, v134
    v_sub_f32 v66, v66, v133
    v_exp_f32 v66, v66
    v_mul_f32 v67, v67, v134
    v_sub_f32 v67, v67, v133
    v_exp_f32 v67, v67
    v_cvt_pk_bf16_f32 v82, v64, v65
    v_mfma_f32_32x32x16_bf16 v[116:131], v[20:23], v[76:79], v[116:131]
    v_mul_f32 v36, v36, v134
    v_sub_f32 v36, v36, v132
    v_exp_f32 v36, v36
    v_mul_f32 v37, v37, v134
    v_sub_f32 v37, v37, v132
    v_exp_f32 v37, v37
    v_cvt_pk_bf16_f32 v83, v66, v67
    v_mul_f32 v38, v38, v134
    v_sub_f32 v38, v38, v132
    v_exp_f32 v38, v38
    v_mul_f32 v39, v39, v134
    v_sub_f32 v39, v39, v132
    v_exp_f32 v39, v39
    v_cvt_pk_bf16_f32 v68, v36, v37
    v_mfma_f32_32x32x16_f16 v[52:67], v[12:15], v[88:91], 0
    s_bitcmp1_b32 s35, s33
    v_mul_f32 v40, v40, v134
    v_sub_f32 v40, v40, v132
    v_exp_f32 v40, v40
    v_mul_f32 v41, v41, v134
    v_sub_f32 v41, v41, v132
    v_exp_f32 v41, v41
    v_cvt_pk_bf16_f32 v69, v38, v39
    v_mul_f32 v42, v42, v134
    v_sub_f32 v42, v42, v132
    v_exp_f32 v42, v42
    v_mul_f32 v43, v43, v134
    v_sub_f32 v43, v43, v132
    v_exp_f32 v43, v43
    v_cvt_pk_bf16_f32 v70, v40, v41
    v_mfma_f32_32x32x16_f16 v[52:67], v[16:19], v[96:99], v[52:67]
    v_mul_f32 v44, v44, v134
    v_sub_f32 v44, v44, v132
    v_exp_f32 v44, v44
    v_mul_f32 v45, v45, v134
    v_sub_f32 v45, v45, v132
    v_exp_f32 v45, v45
    v_cvt_pk_bf16_f32 v71, v42, v43
    v_mul_f32 v46, v46, v134
    v_sub_f32 v46, v46, v132
    v_exp_f32 v46, v46
    v_mul_f32 v47, v47, v134
    v_sub_f32 v47, v47, v132
    v_exp_f32 v47, v47
    v_cvt_pk_bf16_f32 v72, v44, v45
    v_mfma_f32_32x32x16_bf16 v[116:131], v[24:27], v[80:83], v[116:131]
    s_waitcnt lgkmcnt(0)
    s_cbranch_scc0 L_nobar_s7
    s_branch L_c1wait_s
L_nobar_s7:
    ds_read_b128 v[4:7], v1 offset:32768
    ds_read_b128 v[8:11], v1 offset:33792
    v_mul_f32 v48, v48, v134
    v_sub_f32 v48, v48, v132
    v_exp_f32 v48, v48
    v_mul_f32 v49, v49, v134
    v_sub_f32 v49, v49, v132
    v_exp_f32 v49, v49
    v_cvt_pk_bf16_f32 v73, v46, v47
    v_mul_f32 v50, v50, v134
    v_sub_f32 v50, v50, v132
    v_exp_f32 v50, v50
    v_mul_f32 v51, v51, v134
    v_sub_f32 v51, v51, v132
    v_exp_f32 v51, v51
    v_cvt_pk_bf16_f32 v74, v48, v49
    v_mfma_f32_32x32x16_bf16 v[100:115], v[28:31], v[68:71], v[100:115]
    ds_read_b128 v[20:23], v1 offset:49152
    v_mul_f32 v52, v52, v134
    v_sub_f32 v52, v52, v133
    v_exp_f32 v52, v52
    v_mul_f32 v53, v53, v134
    v_sub_f32 v53, v53, v133
    v_exp_f32 v53, v53
    v_cvt_pk_bf16_f32 v75, v50, v51
    v_mul_f32 v54, v54, v134
    v_sub_f32 v54, v54, v133
    v_exp_f32 v54, v54
    v_mul_f32 v55, v55, v134
    v_sub_f32 v55, v55, v133
    v_exp_f32 v55, v55
    v_cvt_pk_bf16_f32 v76, v52, v53
    s_waitcnt lgkmcnt(1)
    v_mfma_f32_32x32x16_f16 v[36:51], v[4:7], v[84:87], 0
    ds_read_b128 v[24:27], v1 offset:50176
    v_mul_f32 v56, v56, v134
    v_sub_f32 v56, v56, v133
    v_exp_f32 v56, v56
    v_mul_f32 v57, v57, v134
    v_sub_f32 v57, v57, v133
    v_exp_f32 v57, v57
    v_cvt_pk_bf16_f32 v77, v54, v55
    v_mul_f32 v58, v58, v134
    v_sub_f32 v58, v58, v133
    v_exp_f32 v58, v58
    v_mul_f32 v59, v59, v134
    v_sub_f32 v59, v59, v133
    v_exp_f32 v59, v59
    v_cvt_pk_bf16_f32 v78, v56, v57
    v_mfma_f32_32x32x16_f16 v[36:51], v[8:11], v[92:95], v[36:51]
    ds_read_b128 v[12:15], v1 offset:34816
    v_mul_f32 v60, v60, v134
    v_sub_f32 v60, v60, v133
    v_exp_f32 v60, v60
    v_mul_f32 v61, v61, v134
    v_sub_f32 v61, v61, v133
    v_exp_f32 v61, v61
    v_cvt_pk_bf16_f32 v79, v58, v59
    v_mul_f32 v62, v62, v134
    v_sub_f32 v62, v62, v133
    v_exp_f32 v62, v62
    v_mul_f32 v63, v63, v134
    v_sub_f32 v63, v63, v133
    v_exp_f32 v63, v63
    v_cvt_pk_bf16_f32 v80, v60, v61
    v_mfma_f32_32x32x16_bf16 v[100:115], v[32:35], v[72:75], v[100:115]
    ds_read_b128 v[16:19], v1 offset:35840
    v_mul_f32 v64, v64, v134
    v_sub_f32 v64, v64, v133
    v_exp_f32 v64, v64
    v_mul_f32 v65, v65, v134
    v_sub_f32 v65, v65, v133
    v_exp_f32 v65, v65
    v_cvt_pk_bf16_f32 v81, v62, v63
    v_mul_f32 v66, v66, v134
    v_sub_f32 v66, v66, v133
    v_exp_f32 v66, v66
    v_mul_f32 v67, v67, v134
    v_sub_f32 v67, v67, v133
    v_exp_f32 v67, v67
    v_cvt_pk_bf16_f32 v82, v64, v65
    v_mfma_f32_32x32x16_bf16 v[116:131], v[28:31], v[76:79], v[116:131]
    v_mul_f32 v36, v36, v134
    v_sub_f32 v36, v36, v132
    v_exp_f32 v36, v36
    v_mul_f32 v37, v37, v134
    v_sub_f32 v37, v37, v132
    v_exp_f32 v37, v37
    v_cvt_pk_bf16_f32 v83, v66, v67
    v_mul_f32 v38, v38, v134
    v_sub_f32 v38, v38, v132
    v_exp_f32 v38, v38
    v_mul_f32 v39, v39, v134
    v_sub_f32 v39, v39, v132
    v_exp_f32 v39, v39
    v_cvt_pk_bf16_f32 v68, v36, v37
    v_mfma_f32_32x32x16_f16 v[52:67], v[4:7], v[88:91], 0
    v_mul_f32 v40, v40, v134
    v_sub_f32 v40, v40, v132
    v_exp_f32 v40, v40
    v_mul_f32 v41, v41, v134
    v_sub_f32 v41, v41, v132
    v_exp_f32 v41, v41
    v_cvt_pk_bf16_f32 v69, v38, v39
    v_mul_f32 v42, v42, v134
    v_sub_f32 v42, v42, v132
    v_exp_f32 v42, v42
    v_mul_f32 v43, v43, v134
    v_sub_f32 v43, v43, v132
    v_exp_f32 v43, v43
    v_cvt_pk_bf16_f32 v70, v40, v41
    v_mfma_f32_32x32x16_f16 v[52:67], v[8:11], v[96:99], v[52:67]
    v_mul_f32 v44, v44, v134
    v_sub_f32 v44, v44, v132
    v_exp_f32 v44, v44
    v_mul_f32 v45, v45, v134
    v_sub_f32 v45, v45, v132
    v_exp_f32 v45, v45
    v_cvt_pk_bf16_f32 v71, v42, v43
    v_mul_f32 v46, v46, v134
    v_sub_f32 v46, v46, v132
    v_exp_f32 v46, v46
    v_mul_f32 v47, v47, v134
    v_sub_f32 v47, v47, v132
    v_exp_f32 v47, v47
    v_cvt_pk_bf16_f32 v72, v44, v45
    v_mfma_f32_32x32x16_bf16 v[116:131], v[32:35], v[80:83], v[116:131]
    s_waitcnt lgkmcnt(0)
    v_mul_f32 v48, v48, v134
    v_sub_f32 v48, v48, v132
    v_exp_f32 v48, v48
    v_mul_f32 v49, v49, v134
    v_sub_f32 v49, v49, v132
    v_exp_f32 v49, v49
    v_cvt_pk_bf16_f32 v73, v46, v47
    v_mul_f32 v50, v50, v134
    v_sub_f32 v50, v50, v132
    v_exp_f32 v50, v50
    v_mul_f32 v51, v51, v134
    v_sub_f32 v51, v51, v132
    v_exp_f32 v51, v51
    v_cvt_pk_bf16_f32 v74, v48, v49
    v_mfma_f32_32x32x16_bf16 v[100:115], v[20:23], v[68:71], v[100:115]
    ds_read_b128 v[28:31], v1 offset:51200
    v_mul_f32 v52, v52, v134
    v_sub_f32 v52, v52, v133
    v_exp_f32 v52, v52
    v_mul_f32 v53, v53, v134
    v_sub_f32 v53, v53, v133
    v_exp_f32 v53, v53
    v_cvt_pk_bf16_f32 v75, v50, v51
    v_mul_f32 v54, v54, v134
    v_sub_f32 v54, v54, v133
    v_exp_f32 v54, v54
    v_mul_f32 v55, v55, v134
    v_sub_f32 v55, v55, v133
    v_exp_f32 v55, v55
    v_cvt_pk_bf16_f32 v76, v52, v53
    v_mfma_f32_32x32x16_f16 v[36:51], v[12:15], v[84:87], 0
    ds_read_b128 v[32:35], v1 offset:52224
    v_mul_f32 v56, v56, v134
    v_sub_f32 v56, v56, v133
    v_exp_f32 v56, v56
    v_mul_f32 v57, v57, v134
    v_sub_f32 v57, v57, v133
    v_exp_f32 v57, v57
    v_cvt_pk_bf16_f32 v77, v54, v55
    v_mul_f32 v58, v58, v134
    v_sub_f32 v58, v58, v133
    v_exp_f32 v58, v58
    v_mul_f32 v59, v59, v134
    v_sub_f32 v59, v59, v133
    v_exp_f32 v59, v59
    v_cvt_pk_bf16_f32 v78, v56, v57
    v_mfma_f32_32x32x16_f16 v[36:51], v[16:19], v[92:95], v[36:51]
    ds_read_b128 v[4:7], v1 offset:36864
    v_mul_f32 v60, v60, v134
    v_sub_f32 v60, v60, v133
    v_exp_f32 v60, v60
    v_mul_f32 v61, v61, v134
    v_sub_f32 v61, v61, v133
    v_exp_f32 v61, v61
    v_cvt_pk_bf16_f32 v79, v58, v59
    v_mul_f32 v62, v62, v134
    v_sub_f32 v62, v62, v133
    v_exp_f32 v62, v62
    v_mul_f32 v63, v63, v134
    v_sub_f32 v63, v63, v133
    v_exp_f32 v63, v63
    v_cvt_pk_bf16_f32 v80, v60, v61
    v_mfma_f32_32x32x16_bf16 v[100:115], v[24:27], v[72:75], v[100:115]
    ds_read_b128 v[8:11], v1 offset:37888
    v_mul_f32 v64, v64, v134
    v_sub_f32 v64, v64, v133
    v_exp_f32 v64, v64
    v_mul_f32 v65, v65, v134
    v_sub_f32 v65, v65, v133
    v_exp_f32 v65, v65
    v_cvt_pk_bf16_f32 v81, v62, v63
    v_mul_f32 v66, v66, v134
    v_sub_f32 v66, v66, v133
    v_exp_f32 v66, v66
    v_mul_f32 v67, v67, v134
    v_sub_f32 v67, v67, v133
    v_exp_f32 v67, v67
    v_cvt_pk_bf16_f32 v82, v64, v65
    v_mfma_f32_32x32x16_bf16 v[116:131], v[20:23], v[76:79], v[116:131]
    v_mul_f32 v36, v36, v134
    v_sub_f32 v36, v36, v132
    v_exp_f32 v36, v36
    v_mul_f32 v37, v37, v134
    v_sub_f32 v37, v37, v132
    v_exp_f32 v37, v37
    v_cvt_pk_bf16_f32 v83, v66, v67
    v_mul_f32 v38, v38, v134
    v_sub_f32 v38, v38, v132
    v_exp_f32 v38, v38
    v_mul_f32 v39, v39, v134
    v_sub_f32 v39, v39, v132
    v_exp_f32 v39, v39
    v_cvt_pk_bf16_f32 v68, v36, v37
    v_mfma_f32_32x32x16_f16 v[52:67], v[12:15], v[88:91], 0
    v_mul_f32 v40, v40, v134
    v_sub_f32 v40, v40, v132
    v_exp_f32 v40, v40
    v_mul_f32 v41, v41, v134
    v_sub_f32 v41, v41, v132
    v_exp_f32 v41, v41
    v_cvt_pk_bf16_f32 v69, v38, v39
    v_mul_f32 v42, v42, v134
    v_sub_f32 v42, v42, v132
    v_exp_f32 v42, v42
    v_mul_f32 v43, v43, v134
    v_sub_f32 v43, v43, v132
    v_exp_f32 v43, v43
    v_cvt_pk_bf16_f32 v70, v40, v41
    v_mfma_f32_32x32x16_f16 v[52:67], v[16:19], v[96:99], v[52:67]
    v_mul_f32 v44, v44, v134
    v_sub_f32 v44, v44, v132
    v_exp_f32 v44, v44
    v_mul_f32 v45, v45, v134
    v_sub_f32 v45, v45, v132
    v_exp_f32 v45, v45
    v_cvt_pk_bf16_f32 v71, v42, v43
    v_mul_f32 v46, v46, v134
    v_sub_f32 v46, v46, v132
    v_exp_f32 v46, v46
    v_mul_f32 v47, v47, v134
    v_sub_f32 v47, v47, v132
    v_exp_f32 v47, v47
    v_cvt_pk_bf16_f32 v72, v44, v45
    v_mfma_f32_32x32x16_bf16 v[116:131], v[24:27], v[80:83], v[116:131]
    s_waitcnt lgkmcnt(0)
    v_mul_f32 v48, v48, v134
    v_sub_f32 v48, v48, v132
    v_exp_f32 v48, v48
    v_mul_f32 v49, v49, v134
    v_sub_f32 v49, v49, v132
    v_exp_f32 v49, v49
    v_cvt_pk_bf16_f32 v73, v46, v47
    v_mul_f32 v50, v50, v134
    v_sub_f32 v50, v50, v132
    v_exp_f32 v50, v50
    v_mul_f32 v51, v51, v134
    v_sub_f32 v51, v51, v132
    v_exp_f32 v51, v51
    v_cvt_pk_bf16_f32 v74, v48, v49
    v_mfma_f32_32x32x16_bf16 v[100:115], v[28:31], v[68:71], v[100:115]
    ds_read_b128 v[20:23], v1 offset:53248
    v_mul_f32 v52, v52, v134
    v_sub_f32 v52, v52, v133
    v_exp_f32 v52, v52
    v_mul_f32 v53, v53, v134
    v_sub_f32 v53, v53, v133
    v_exp_f32 v53, v53
    v_cvt_pk_bf16_f32 v75, v50, v51
    v_mul_f32 v54, v54, v134
    v_sub_f32 v54, v54, v133
    v_exp_f32 v54, v54
    v_mul_f32 v55, v55, v134
    v_sub_f32 v55, v55, v133
    v_exp_f32 v55, v55
    v_cvt_pk_bf16_f32 v76, v52, v53
    v_mfma_f32_32x32x16_f16 v[36:51], v[4:7], v[84:87], 0
    ds_read_b128 v[24:27], v1 offset:54272
    v_mul_f32 v56, v56, v134
    v_sub_f32 v56, v56, v133
    v_exp_f32 v56, v56
    v_mul_f32 v57, v57, v134
    v_sub_f32 v57, v57, v133
    v_exp_f32 v57, v57
    v_cvt_pk_bf16_f32 v77, v54, v55
    v_mul_f32 v58, v58, v134
    v_sub_f32 v58, v58, v133
    v_exp_f32 v58, v58
    v_mul_f32 v59, v59, v134
    v_sub_f32 v59, v59, v133
    v_exp_f32 v59, v59
    v_cvt_pk_bf16_f32 v78, v56, v57
    v_mfma_f32_32x32x16_f16 v[36:51], v[8:11], v[92:95], v[36:51]
    ds_read_b128 v[12:15], v1 offset:38912
    v_mul_f32 v60, v60, v134
    v_sub_f32 v60, v60, v133
    v_exp_f32 v60, v60
    v_mul_f32 v61, v61, v134
    v_sub_f32 v61, v61, v133
    v_exp_f32 v61, v61
    v_cvt_pk_bf16_f32 v79, v58, v59
    v_mul_f32 v62, v62, v134
    v_sub_f32 v62, v62, v133
    v_exp_f32 v62, v62
    v_mul_f32 v63, v63, v134
    v_sub_f32 v63, v63, v133
    v_exp_f32 v63, v63
    v_cvt_pk_bf16_f32 v80, v60, v61
    v_mfma_f32_32x32x16_bf16 v[100:115], v[32:35], v[72:75], v[100:115]
    ds_read_b128 v[16:19], v1 offset:39936
    v_mul_f32 v64, v64, v134
    v_sub_f32 v64, v64, v133
    v_exp_f32 v64, v64
    v_mul_f32 v65, v65, v134
    v_sub_f32 v65, v65, v133
    v_exp_f32 v65, v65
    v_cvt_pk_bf16_f32 v81, v62, v63
    v_mul_f32 v66, v66, v134
    v_sub_f32 v66, v66, v133
    v_exp_f32 v66, v66
    v_mul_f32 v67, v67, v134
    v_sub_f32 v67, v67, v133
    v_exp_f32 v67, v67
    v_cvt_pk_bf16_f32 v82, v64, v65
    v_mfma_f32_32x32x16_bf16 v[116:131], v[28:31], v[76:79], v[116:131]
    v_mul_f32 v36, v36, v134
    v_sub_f32 v36, v36, v132
    v_exp_f32 v36, v36
    v_mul_f32 v37, v37, v134
    v_sub_f32 v37, v37, v132
    v_exp_f32 v37, v37
    v_cvt_pk_bf16_f32 v83, v66, v67
    v_mul_f32 v38, v38, v134
    v_sub_f32 v38, v38, v132
    v_exp_f32 v38, v38
    v_mul_f32 v39, v39, v134
    v_sub_f32 v39, v39, v132
    v_exp_f32 v39, v39
    v_cvt_pk_bf16_f32 v68, v36, v37
    v_mfma_f32_32x32x16_f16 v[52:67], v[4:7], v[88:91], 0
    v_mul_f32 v40, v40, v134
    v_sub_f32 v40, v40, v132
    v_exp_f32 v40, v40
    v_mul_f32 v41, v41, v134
    v_sub_f32 v41, v41, v132
    v_exp_f32 v41, v41
    v_cvt_pk_bf16_f32 v69, v38, v39
    v_mul_f32 v42, v42, v134
    v_sub_f32 v42, v42, v132
    v_exp_f32 v42, v42
    v_mul_f32 v43, v43, v134
    v_sub_f32 v43, v43, v132
    v_exp_f32 v43, v43
    v_cvt_pk_bf16_f32 v70, v40, v41
    v_mfma_f32_32x32x16_f16 v[52:67], v[8:11], v[96:99], v[52:67]
    v_mul_f32 v44, v44, v134
    v_sub_f32 v44, v44, v132
    v_exp_f32 v44, v44
    v_mul_f32 v45, v45, v134
    v_sub_f32 v45, v45, v132
    v_exp_f32 v45, v45
    v_cvt_pk_bf16_f32 v71, v42, v43
    v_mul_f32 v46, v46, v134
    v_sub_f32 v46, v46, v132
    v_exp_f32 v46, v46
    v_mul_f32 v47, v47, v134
    v_sub_f32 v47, v47, v132
    v_exp_f32 v47, v47
    v_cvt_pk_bf16_f32 v72, v44, v45
    v_mfma_f32_32x32x16_bf16 v[116:131], v[32:35], v[80:83], v[116:131]
    s_waitcnt lgkmcnt(0)
    v_mul_f32 v48, v48, v134
    v_sub_f32 v48, v48, v132
    v_exp_f32 v48, v48
    v_mul_f32 v49, v49, v134
    v_sub_f32 v49, v49, v132
    v_exp_f32 v49, v49
    v_cvt_pk_bf16_f32 v73, v46, v47
    v_mul_f32 v50, v50, v134
    v_sub_f32 v50, v50, v132
    v_exp_f32 v50, v50
    v_mul_f32 v51, v51, v134
    v_sub_f32 v51, v51, v132
    v_exp_f32 v51, v51
    v_cvt_pk_bf16_f32 v74, v48, v49
    v_mfma_f32_32x32x16_bf16 v[100:115], v[20:23], v[68:71], v[100:115]
    ds_read_b128 v[28:31], v1 offset:55296
    v_mul_f32 v52, v52, v134
    v_sub_f32 v52, v52, v133
    v_exp_f32 v52, v52
    v_mul_f32 v53, v53, v134
    v_sub_f32 v53, v53, v133
    v_exp_f32 v53, v53
    v_cvt_pk_bf16_f32 v75, v50, v51
    v_mul_f32 v54, v54, v134
    v_sub_f32 v54, v54, v133
    v_exp_f32 v54, v54
    v_mul_f32 v55, v55, v134
    v_sub_f32 v55, v55, v133
    v_exp_f32 v55, v55
    v_cvt_pk_bf16_f32 v76, v52, v53
    v_mfma_f32_32x32x16_f16 v[36:51], v[12:15], v[84:87], 0
    ds_read_b128 v[32:35], v1 offset:56320
    v_mul_f32 v56, v56, v134
    v_sub_f32 v56, v56, v133
    v_exp_f32 v56, v56
    v_mul_f32 v57, v57, v134
    v_sub_f32 v57, v57, v133
    v_exp_f32 v57, v57
    v_cvt_pk_bf16_f32 v77, v54, v55
    v_mul_f32 v58, v58, v134
    v_sub_f32 v58, v58, v133
    v_exp_f32 v58, v58
    v_mul_f32 v59, v59, v134
    v_sub_f32 v59, v59, v133
    v_exp_f32 v59, v59
    v_cvt_pk_bf16_f32 v78, v56, v57
    v_mfma_f32_32x32x16_f16 v[36:51], v[16:19], v[92:95], v[36:51]
    ds_read_b128 v[4:7], v1 offset:40960
    v_mul_f32 v60, v60, v134
    v_sub_f32 v60, v60, v133
    v_exp_f32 v60, v60
    v_mul_f32 v61, v61, v134
    v_sub_f32 v61, v61, v133
    v_exp_f32 v61, v61
    v_cvt_pk_bf16_f32 v79, v58, v59
    v_mul_f32 v62, v62, v134
    v_sub_f32 v62, v62, v133
    v_exp_f32 v62, v62
    v_mul_f32 v63, v63, v134
    v_sub_f32 v63, v63, v133
    v_exp_f32 v63, v63
    v_cvt_pk_bf16_f32 v80, v60, v61
    v_mfma_f32_32x32x16_bf16 v[100:115], v[24:27], v[72:75], v[100:115]
    ds_read_b128 v[8:11], v1 offset:41984
    v_mul_f32 v64, v64, v134
    v_sub_f32 v64, v64, v133
    v_exp_f32 v64, v64
    v_mul_f32 v65, v65, v134
    v_sub_f32 v65, v65, v133
    v_exp_f32 v65, v65
    v_cvt_pk_bf16_f32 v81, v62, v63
    v_mul_f32 v66, v66, v134
    v_sub_f32 v66, v66, v133
    v_exp_f32 v66, v66
    v_mul_f32 v67, v67, v134
    v_sub_f32 v67, v67, v133
    v_exp_f32 v67, v67
    v_cvt_pk_bf16_f32 v82, v64, v65
    v_mfma_f32_32x32x16_bf16 v[116:131], v[20:23], v[76:79], v[116:131]
    v_mul_f32 v36, v36, v134
    v_sub_f32 v36, v36, v132
    v_exp_f32 v36, v36
    v_mul_f32 v37, v37, v134
    v_sub_f32 v37, v37, v132
    v_exp_f32 v37, v37
    v_cvt_pk_bf16_f32 v83, v66, v67
    v_mul_f32 v38, v38, v134
    v_sub_f32 v38, v38, v132
    v_exp_f32 v38, v38
    v_mul_f32 v39, v39, v134
    v_sub_f32 v39, v39, v132
    v_exp_f32 v39, v39
    v_cvt_pk_bf16_f32 v68, v36, v37
    v_mfma_f32_32x32x16_f16 v[52:67], v[12:15], v[88:91], 0
    v_mul_f32 v40, v40, v134
    v_sub_f32 v40, v40, v132
    v_exp_f32 v40, v40
    v_mul_f32 v41, v41, v134
    v_sub_f32 v41, v41, v132
    v_exp_f32 v41, v41
    v_cvt_pk_bf16_f32 v69, v38, v39
    v_mul_f32 v42, v42, v134
    v_sub_f32 v42, v42, v132
    v_exp_f32 v42, v42
    v_mul_f32 v43, v43, v134
    v_sub_f32 v43, v43, v132
    v_exp_f32 v43, v43
    v_cvt_pk_bf16_f32 v70, v40, v41
    v_mfma_f32_32x32x16_f16 v[52:67], v[16:19], v[96:99], v[52:67]
    v_mul_f32 v44, v44, v134
    v_sub_f32 v44, v44, v132
    v_exp_f32 v44, v44
    v_mul_f32 v45, v45, v134
    v_sub_f32 v45, v45, v132
    v_exp_f32 v45, v45
    v_cvt_pk_bf16_f32 v71, v42, v43
    v_mul_f32 v46, v46, v134
    v_sub_f32 v46, v46, v132
    v_exp_f32 v46, v46
    v_mul_f32 v47, v47, v134
    v_sub_f32 v47, v47, v132
    v_exp_f32 v47, v47
    v_cvt_pk_bf16_f32 v72, v44, v45
    v_mfma_f32_32x32x16_bf16 v[116:131], v[24:27], v[80:83], v[116:131]
    s_waitcnt lgkmcnt(0)
    v_mul_f32 v48, v48, v134
    v_sub_f32 v48, v48, v132
    v_exp_f32 v48, v48
    v_mul_f32 v49, v49, v134
    v_sub_f32 v49, v49, v132
    v_exp_f32 v49, v49
    v_cvt_pk_bf16_f32 v73, v46, v47
    v_mul_f32 v50, v50, v134
    v_sub_f32 v50, v50, v132
    v_exp_f32 v50, v50
    v_mul_f32 v51, v51, v134
    v_sub_f32 v51, v51, v132
    v_exp_f32 v51, v51
    v_cvt_pk_bf16_f32 v74, v48, v49
    v_mfma_f32_32x32x16_bf16 v[100:115], v[28:31], v[68:71], v[100:115]
    ds_read_b128 v[20:23], v1 offset:57344
    v_mul_f32 v52, v52, v134
    v_sub_f32 v52, v52, v133
    v_exp_f32 v52, v52
    v_mul_f32 v53, v53, v134
    v_sub_f32 v53, v53, v133
    v_exp_f32 v53, v53
    v_cvt_pk_bf16_f32 v75, v50, v51
    v_mul_f32 v54, v54, v134
    v_sub_f32 v54, v54, v133
    v_exp_f32 v54, v54
    v_mul_f32 v55, v55, v134
    v_sub_f32 v55, v55, v133
    v_exp_f32 v55, v55
    v_cvt_pk_bf16_f32 v76, v52, v53
    v_mfma_f32_32x32x16_f16 v[36:51], v[4:7], v[84:87], 0
    ds_read_b128 v[24:27], v1 offset:58368
    v_mul_f32 v56, v56, v134
    v_sub_f32 v56, v56, v133
    v_exp_f32 v56, v56
    v_mul_f32 v57, v57, v134
    v_sub_f32 v57, v57, v133
    v_exp_f32 v57, v57
    v_cvt_pk_bf16_f32 v77, v54, v55
    v_mul_f32 v58, v58, v134
    v_sub_f32 v58, v58, v133
    v_exp_f32 v58, v58
    v_mul_f32 v59, v59, v134
    v_sub_f32 v59, v59, v133
    v_exp_f32 v59, v59
    v_cvt_pk_bf16_f32 v78, v56, v57
    v_mfma_f32_32x32x16_f16 v[36:51], v[8:11], v[92:95], v[36:51]
    ds_read_b128 v[12:15], v1 offset:43008
    v_mul_f32 v60, v60, v134
    v_sub_f32 v60, v60, v133
    v_exp_f32 v60, v60
    v_mul_f32 v61, v61, v134
    v_sub_f32 v61, v61, v133
    v_exp_f32 v61, v61
    v_cvt_pk_bf16_f32 v79, v58, v59
    v_mul_f32 v62, v62, v134
    v_sub_f32 v62, v62, v133
    v_exp_f32 v62, v62
    v_mul_f32 v63, v63, v134
    v_sub_f32 v63, v63, v133
    v_exp_f32 v63, v63
    v_cvt_pk_bf16_f32 v80, v60, v61
    v_mfma_f32_32x32x16_bf16 v[100:115], v[32:35], v[72:75], v[100:115]
    ds_read_b128 v[16:19], v1 offset:44032
    v_mul_f32 v64, v64, v134
    v_sub_f32 v64, v64, v133
    v_exp_f32 v64, v64
    v_mul_f32 v65, v65, v134
    v_sub_f32 v65, v65, v133
    v_exp_f32 v65, v65
    v_cvt_pk_bf16_f32 v81, v62, v63
    v_mul_f32 v66, v66, v134
    v_sub_f32 v66, v66, v133
    v_exp_f32 v66, v66
    v_mul_f32 v67, v67, v134
    v_sub_f32 v67, v67, v133
    v_exp_f32 v67, v67
    v_cvt_pk_bf16_f32 v82, v64, v65
    v_mfma_f32_32x32x16_bf16 v[116:131], v[28:31], v[76:79], v[116:131]
    v_mul_f32 v36, v36, v134
    v_sub_f32 v36, v36, v132
    v_exp_f32 v36, v36
    v_mul_f32 v37, v37, v134
    v_sub_f32 v37, v37, v132
    v_exp_f32 v37, v37
    v_cvt_pk_bf16_f32 v83, v66, v67
    v_mul_f32 v38, v38, v134
    v_sub_f32 v38, v38, v132
    v_exp_f32 v38, v38
    v_mul_f32 v39, v39, v134
    v_sub_f32 v39, v39, v132
    v_exp_f32 v39, v39
    v_cvt_pk_bf16_f32 v68, v36, v37
    v_mfma_f32_32x32x16_f16 v[52:67], v[4:7], v[88:91], 0
    v_mul_f32 v40, v40, v134
    v_sub_f32 v40, v40, v132
    v_exp_f32 v40, v40
    v_mul_f32 v41, v41, v134
    v_sub_f32 v41, v41, v132
    v_exp_f32 v41, v41
    v_cvt_pk_bf16_f32 v69, v38, v39
    v_mul_f32 v42, v42, v134
    v_sub_f32 v42, v42, v132
    v_exp_f32 v42, v42
    v_mul_f32 v43, v43, v134
    v_sub_f32 v43, v43, v132
    v_exp_f32 v43, v43
    v_cvt_pk_bf16_f32 v70, v40, v41
    v_mfma_f32_32x32x16_f16 v[52:67], v[8:11], v[96:99], v[52:67]
    v_mul_f32 v44, v44, v134
    v_sub_f32 v44, v44, v132
    v_exp_f32 v44, v44
    v_mul_f32 v45, v45, v134
    v_sub_f32 v45, v45, v132
    v_exp_f32 v45, v45
    v_cvt_pk_bf16_f32 v71, v42, v43
    v_mul_f32 v46, v46, v134
    v_sub_f32 v46, v46, v132
    v_exp_f32 v46, v46
    v_mul_f32 v47, v47, v134
    v_sub_f32 v47, v47, v132
    v_exp_f32 v47, v47
    v_cvt_pk_bf16_f32 v72, v44, v45
    v_mfma_f32_32x32x16_bf16 v[116:131], v[32:35], v[80:83], v[116:131]
    s_waitcnt lgkmcnt(0)
    v_mul_f32 v48, v48, v134
    v_sub_f32 v48, v48, v132
    v_exp_f32 v48, v48
    v_mul_f32 v49, v49, v134
    v_sub_f32 v49, v49, v132
    v_exp_f32 v49, v49
    v_cvt_pk_bf16_f32 v73, v46, v47
    v_mul_f32 v50, v50, v134
    v_sub_f32 v50, v50, v132
    v_exp_f32 v50, v50
    v_mul_f32 v51, v51, v134
    v_sub_f32 v51, v51, v132
    v_exp_f32 v51, v51
    v_cvt_pk_bf16_f32 v74, v48, v49
    v_mfma_f32_32x32x16_bf16 v[100:115], v[20:23], v[68:71], v[100:115]
    ds_read_b128 v[28:31], v1 offset:59392
    v_mul_f32 v52, v52, v134
    v_sub_f32 v52, v52, v133
    v_exp_f32 v52, v52
    v_mul_f32 v53, v53, v134
    v_sub_f32 v53, v53, v133
    v_exp_f32 v53, v53
    v_cvt_pk_bf16_f32 v75, v50, v51
    v_mul_f32 v54, v54, v134
    v_sub_f32 v54, v54, v133
    v_exp_f32 v54, v54
    v_mul_f32 v55, v55, v134
    v_sub_f32 v55, v55, v133
    v_exp_f32 v55, v55
    v_cvt_pk_bf16_f32 v76, v52, v53
    v_mfma_f32_32x32x16_f16 v[36:51], v[12:15], v[84:87], 0
    ds_read_b128 v[32:35], v1 offset:60416
    v_mul_f32 v56, v56, v134
    v_sub_f32 v56, v56, v133
    v_exp_f32 v56, v56
    v_mul_f32 v57, v57, v134
    v_sub_f32 v57, v57, v133
    v_exp_f32 v57, v57
    v_cvt_pk_bf16_f32 v77, v54, v55
    v_mul_f32 v58, v58, v134
    v_sub_f32 v58, v58, v133
    v_exp_f32 v58, v58
    v_mul_f32 v59, v59, v134
    v_sub_f32 v59, v59, v133
    v_exp_f32 v59, v59
    v_cvt_pk_bf16_f32 v78, v56, v57
    v_mfma_f32_32x32x16_f16 v[36:51], v[16:19], v[92:95], v[36:51]
    ds_read_b128 v[4:7], v1 offset:45056
    v_mul_f32 v60, v60, v134
    v_sub_f32 v60, v60, v133
    v_exp_f32 v60, v60
    v_mul_f32 v61, v61, v134
    v_sub_f32 v61, v61, v133
    v_exp_f32 v61, v61
    v_cvt_pk_bf16_f32 v79, v58, v59
    v_mul_f32 v62, v62, v134
    v_sub_f32 v62, v62, v133
    v_exp_f32 v62, v62
    v_mul_f32 v63, v63, v134
    v_sub_f32 v63, v63, v133
    v_exp_f32 v63, v63
    v_cvt_pk_bf16_f32 v80, v60, v61
    v_mfma_f32_32x32x16_bf16 v[100:115], v[24:27], v[72:75], v[100:115]
    ds_read_b128 v[8:11], v1 offset:46080
    v_mul_f32 v64, v64, v134
    v_sub_f32 v64, v64, v133
    v_exp_f32 v64, v64
    v_mul_f32 v65, v65, v134
    v_sub_f32 v65, v65, v133
    v_exp_f32 v65, v65
    v_cvt_pk_bf16_f32 v81, v62, v63
    v_mul_f32 v66, v66, v134
    v_sub_f32 v66, v66, v133
    v_exp_f32 v66, v66
    v_mul_f32 v67, v67, v134
    v_sub_f32 v67, v67, v133
    v_exp_f32 v67, v67
    v_cvt_pk_bf16_f32 v82, v64, v65
    v_mfma_f32_32x32x16_bf16 v[116:131], v[20:23], v[76:79], v[116:131]
    v_mul_f32 v36, v36, v134
    v_sub_f32 v36, v36, v132
    v_exp_f32 v36, v36
    v_mul_f32 v37, v37, v134
    v_sub_f32 v37, v37, v132
    v_exp_f32 v37, v37
    v_cvt_pk_bf16_f32 v83, v66, v67
    v_mul_f32 v38, v38, v134
    v_sub_f32 v38, v38, v132
    v_exp_f32 v38, v38
    v_mul_f32 v39, v39, v134
    v_sub_f32 v39, v39, v132
    v_exp_f32 v39, v39
    v_cvt_pk_bf16_f32 v68, v36, v37
    v_mfma_f32_32x32x16_f16 v[52:67], v[12:15], v[88:91], 0
    v_mul_f32 v40, v40, v134
    v_sub_f32 v40, v40, v132
    v_exp_f32 v40, v40
    v_mul_f32 v41, v41, v134
    v_sub_f32 v41, v41, v132
    v_exp_f32 v41, v41
    v_cvt_pk_bf16_f32 v69, v38, v39
    v_mul_f32 v42, v42, v134
    v_sub_f32 v42, v42, v132
    v_exp_f32 v42, v42
    v_mul_f32 v43, v43, v134
    v_sub_f32 v43, v43, v132
    v_exp_f32 v43, v43
    v_cvt_pk_bf16_f32 v70, v40, v41
    v_mfma_f32_32x32x16_f16 v[52:67], v[16:19], v[96:99], v[52:67]
    v_mul_f32 v44, v44, v134
    v_sub_f32 v44, v44, v132
    v_exp_f32 v44, v44
    v_mul_f32 v45, v45, v134
    v_sub_f32 v45, v45, v132
    v_exp_f32 v45, v45
    v_cvt_pk_bf16_f32 v71, v42, v43
    v_mul_f32 v46, v46, v134
    v_sub_f32 v46, v46, v132
    v_exp_f32 v46, v46
    v_mul_f32 v47, v47, v134
    v_sub_f32 v47, v47, v132
    v_exp_f32 v47, v47
    v_cvt_pk_bf16_f32 v72, v44, v45
    v_mfma_f32_32x32x16_bf16 v[116:131], v[24:27], v[80:83], v[116:131]
    s_waitcnt lgkmcnt(0)
    v_mul_f32 v48, v48, v134
    v_sub_f32 v48, v48, v132
    v_exp_f32 v48, v48
    v_mul_f32 v49, v49, v134
    v_sub_f32 v49, v49, v132
    v_exp_f32 v49, v49
    v_cvt_pk_bf16_f32 v73, v46, v47
    v_mul_f32 v50, v50, v134
    v_sub_f32 v50, v50, v132
    v_exp_f32 v50, v50
    v_mul_f32 v51, v51, v134
    v_sub_f32 v51, v51, v132
    v_exp_f32 v51, v51
    v_cvt_pk_bf16_f32 v74, v48, v49
    v_mfma_f32_32x32x16_bf16 v[100:115], v[28:31], v[68:71], v[100:115]
    ds_read_b128 v[20:23], v1 offset:61440
    v_mul_f32 v52, v52, v134
    v_sub_f32 v52, v52, v133
    v_exp_f32 v52, v52
    v_mul_f32 v53, v53, v134
    v_sub_f32 v53, v53, v133
    v_exp_f32 v53, v53
    v_cvt_pk_bf16_f32 v75, v50, v51
    v_mul_f32 v54, v54, v134
    v_sub_f32 v54, v54, v133
    v_exp_f32 v54, v54
    v_mul_f32 v55, v55, v134
    v_sub_f32 v55, v55, v133
    v_exp_f32 v55, v55
    v_cvt_pk_bf16_f32 v76, v52, v53
    v_mfma_f32_32x32x16_f16 v[36:51], v[4:7], v[84:87], 0
    ds_read_b128 v[24:27], v1 offset:62464
    v_mul_f32 v56, v56, v134
    v_sub_f32 v56, v56, v133
    v_exp_f32 v56, v56
    v_mul_f32 v57, v57, v134
    v_sub_f32 v57, v57, v133
    v_exp_f32 v57, v57
    v_cvt_pk_bf16_f32 v77, v54, v55
    v_mul_f32 v58, v58, v134
    v_sub_f32 v58, v58, v133
    v_exp_f32 v58, v58
    v_mul_f32 v59, v59, v134
    v_sub_f32 v59, v59, v133
    v_exp_f32 v59, v59
    v_cvt_pk_bf16_f32 v78, v56, v57
    v_mfma_f32_32x32x16_f16 v[36:51], v[8:11], v[92:95], v[36:51]
    ds_read_b128 v[12:15], v1 offset:47104
    v_mul_f32 v60, v60, v134
    v_sub_f32 v60, v60, v133
    v_exp_f32 v60, v60
    v_mul_f32 v61, v61, v134
    v_sub_f32 v61, v61, v133
    v_exp_f32 v61, v61
    v_cvt_pk_bf16_f32 v79, v58, v59
    v_mul_f32 v62, v62, v134
    v_sub_f32 v62, v62, v133
    v_exp_f32 v62, v62
    v_mul_f32 v63, v63, v134
    v_sub_f32 v63, v63, v133
    v_exp_f32 v63, v63
    v_cvt_pk_bf16_f32 v80, v60, v61
    v_mfma_f32_32x32x16_bf16 v[100:115], v[32:35], v[72:75], v[100:115]
    ds_read_b128 v[16:19], v1 offset:48128
    v_mul_f32 v64, v64, v134
    v_sub_f32 v64, v64, v133
    v_exp_f32 v64, v64
    v_mul_f32 v65, v65, v134
    v_sub_f32 v65, v65, v133
    v_exp_f32 v65, v65
    v_cvt_pk_bf16_f32 v81, v62, v63
    v_mul_f32 v66, v66, v134
    v_sub_f32 v66, v66, v133
    v_exp_f32 v66, v66
    v_mul_f32 v67, v67, v134
    v_sub_f32 v67, v67, v133
    v_exp_f32 v67, v67
    v_cvt_pk_bf16_f32 v82, v64, v65
    v_mfma_f32_32x32x16_bf16 v[116:131], v[28:31], v[76:79], v[116:131]
    v_mul_f32 v36, v36, v134
    v_sub_f32 v36, v36, v132
    v_exp_f32 v36, v36
    v_mul_f32 v37, v37, v134
    v_sub_f32 v37, v37, v132
    v_exp_f32 v37, v37
    v_cvt_pk_bf16_f32 v83, v66, v67
    v_mul_f32 v38, v38, v134
    v_sub_f32 v38, v38, v132
    v_exp_f32 v38, v38
    v_mul_f32 v39, v39, v134
    v_sub_f32 v39, v39, v132
    v_exp_f32 v39, v39
    v_cvt_pk_bf16_f32 v68, v36, v37
    v_mfma_f32_32x32x16_f16 v[52:67], v[4:7], v[88:91], 0
    v_mul_f32 v40, v40, v134
    v_sub_f32 v40, v40, v132
    v_exp_f32 v40, v40
    v_mul_f32 v41, v41, v134
    v_sub_f32 v41, v41, v132
    v_exp_f32 v41, v41
    v_cvt_pk_bf16_f32 v69, v38, v39
    v_mul_f32 v42, v42, v134
    v_sub_f32 v42, v42, v132
    v_exp_f32 v42, v42
    v_mul_f32 v43, v43, v134
    v_sub_f32 v43, v43, v132
    v_exp_f32 v43, v43
    v_cvt_pk_bf16_f32 v70, v40, v41
    v_mfma_f32_32x32x16_f16 v[52:67], v[8:11], v[96:99], v[52:67]
    v_mul_f32 v44, v44, v134
    v_sub_f32 v44, v44, v132
    v_exp_f32 v44, v44
    v_mul_f32 v45, v45, v134
    v_sub_f32 v45, v45, v132
    v_exp_f32 v45, v45
    v_cvt_pk_bf16_f32 v71, v42, v43
    v_mul_f32 v46, v46, v134
    v_sub_f32 v46, v46, v132
    v_exp_f32 v46, v46
    v_mul_f32 v47, v47, v134
    v_sub_f32 v47, v47, v132
    v_exp_f32 v47, v47
    v_cvt_pk_bf16_f32 v72, v44, v45
    v_mfma_f32_32x32x16_bf16 v[116:131], v[32:35], v[80:83], v[116:131]
    s_waitcnt lgkmcnt(0)
    v_mul_f32 v48, v48, v134
    v_sub_f32 v48, v48, v132
    v_exp_f32 v48, v48
    v_mul_f32 v49, v49, v134
    v_sub_f32 v49, v49, v132
    v_exp_f32 v49, v49
    v_cvt_pk_bf16_f32 v73, v46, v47
    v_mul_f32 v50, v50, v134
    v_sub_f32 v50, v50, v132
    v_exp_f32 v50, v50
    v_mul_f32 v51, v51, v134
    v_sub_f32 v51, v51, v132
    v_exp_f32 v51, v51
    v_cvt_pk_bf16_f32 v74, v48, v49
    v_mfma_f32_32x32x16_bf16 v[100:115], v[20:23], v[68:71], v[100:115]
    ds_read_b128 v[28:31], v1 offset:63488
    v_mul_f32 v52, v52, v134
    v_sub_f32 v52, v52, v133
    v_exp_f32 v52, v52
    v_mul_f32 v53, v53, v134
    v_sub_f32 v53, v53, v133
    v_exp_f32 v53, v53
    v_cvt_pk_bf16_f32 v75, v50, v51
    v_mul_f32 v54, v54, v134
    v_sub_f32 v54, v54, v133
    v_exp_f32 v54, v54
    v_mul_f32 v55, v55, v134
    v_sub_f32 v55, v55, v133
    v_exp_f32 v55, v55
    v_cvt_pk_bf16_f32 v76, v52, v53
    v_mfma_f32_32x32x16_f16 v[36:51], v[12:15], v[84:87], 0
    ds_read_b128 v[32:35], v1 offset:64512
    v_mul_f32 v56, v56, v134
    v_sub_f32 v56, v56, v133
    v_exp_f32 v56, v56
    v_mul_f32 v57, v57, v134
    v_sub_f32 v57, v57, v133
    v_exp_f32 v57, v57
    v_cvt_pk_bf16_f32 v77, v54, v55
    v_mul_f32 v58, v58, v134
    v_sub_f32 v58, v58, v133
    v_exp_f32 v58, v58
    v_mul_f32 v59, v59, v134
    v_sub_f32 v59, v59, v133
    v_exp_f32 v59, v59
    v_cvt_pk_bf16_f32 v78, v56, v57
    v_mfma_f32_32x32x16_f16 v[36:51], v[16:19], v[92:95], v[36:51]
    v_mul_f32 v60, v60, v134
    v_sub_f32 v60, v60, v133
    v_exp_f32 v60, v60
    v_mul_f32 v61, v61, v134
    v_sub_f32 v61, v61, v133
    v_exp_f32 v61, v61
    v_cvt_pk_bf16_f32 v79, v58, v59
    v_mul_f32 v62, v62, v134
    v_sub_f32 v62, v62, v133
    v_exp_f32 v62, v62
    v_mul_f32 v63, v63, v134
    v_sub_f32 v63, v63, v133
    v_exp_f32 v63, v63
    v_cvt_pk_bf16_f32 v80, v60, v61
    v_mfma_f32_32x32x16_bf16 v[100:115], v[24:27], v[72:75], v[100:115]
    v_mul_f32 v64, v64, v134
    v_sub_f32 v64, v64, v133
    v_exp_f32 v64, v64
    v_mul_f32 v65, v65, v134
    v_sub_f32 v65, v65, v133
    v_exp_f32 v65, v65
    v_cvt_pk_bf16_f32 v81, v62, v63
    v_mul_f32 v66, v66, v134
    v_sub_f32 v66, v66, v133
    v_exp_f32 v66, v66
    v_mul_f32 v67, v67, v134
    v_sub_f32 v67, v67, v133
    v_exp_f32 v67, v67
    v_cvt_pk_bf16_f32 v82, v64, v65
    v_mfma_f32_32x32x16_bf16 v[116:131], v[20:23], v[76:79], v[116:131]
    v_mul_f32 v36, v36, v134
    v_sub_f32 v36, v36, v132
    v_exp_f32 v36, v36
    v_mul_f32 v37, v37, v134
    v_sub_f32 v37, v37, v132
    v_exp_f32 v37, v37
    v_cvt_pk_bf16_f32 v83, v66, v67
    v_mul_f32 v38, v38, v134
    v_sub_f32 v38, v38, v132
    v_exp_f32 v38, v38
    v_mul_f32 v39, v39, v134
    v_sub_f32 v39, v39, v132
    v_exp_f32 v39, v39
    v_cvt_pk_bf16_f32 v68, v36, v37
    v_mfma_f32_32x32x16_f16 v[52:67], v[12:15], v[88:91], 0
    s_bitcmp1_b32 s48, s33
    v_mul_f32 v40, v40, v134
    v_sub_f32 v40, v40, v132
    v_exp_f32 v40, v40
    v_mul_f32 v41, v41, v134
    v_sub_f32 v41, v41, v132
    v_exp_f32 v41, v41
    v_cvt_pk_bf16_f32 v69, v38, v39
    v_mul_f32 v42, v42, v134
    v_sub_f32 v42, v42, v132
    v_exp_f32 v42, v42
    v_mul_f32 v43, v43, v134
    v_sub_f32 v43, v43, v132
    v_exp_f32 v43, v43
    v_cvt_pk_bf16_f32 v70, v40, v41
    v_mfma_f32_32x32x16_f16 v[52:67], v[16:19], v[96:99], v[52:67]
    v_mul_f32 v44, v44, v134
    v_sub_f32 v44, v44, v132
    v_exp_f32 v44, v44
    v_mul_f32 v45, v45, v134
    v_sub_f32 v45, v45, v132
    v_exp_f32 v45, v45
    v_cvt_pk_bf16_f32 v71, v42, v43
    v_mul_f32 v46, v46, v134
    v_sub_f32 v46, v46, v132
    v_exp_f32 v46, v46
    v_mul_f32 v47, v47, v134
    v_sub_f32 v47, v47, v132
    v_exp_f32 v47, v47
    v_cvt_pk_bf16_f32 v72, v44, v45
    v_mfma_f32_32x32x16_bf16 v[116:131], v[24:27], v[80:83], v[116:131]
    s_waitcnt lgkmcnt(0)
    s_cbranch_scc0 L_nobar_s15
    s_barrier
L_nobar_s15:
    v_xor_b32 v1, 65536, v1
    ds_read_b128 v[4:7], v1 offset:0
    ds_read_b128 v[8:11], v1 offset:1024
    v_mul_f32 v48, v48, v134
    v_sub_f32 v48, v48, v132
    v_exp_f32 v48, v48
    v_mul_f32 v49, v49, v134
    v_sub_f32 v49, v49, v132
    v_exp_f32 v49, v49
    v_cvt_pk_bf16_f32 v73, v46, v47
    v_mul_f32 v50, v50, v134
    v_sub_f32 v50, v50, v132
    v_exp_f32 v50, v50
    v_mul_f32 v51, v51, v134
    v_sub_f32 v51, v51, v132
    v_exp_f32 v51, v51
    v_cvt_pk_bf16_f32 v74, v48, v49
    v_mfma_f32_32x32x16_bf16 v[100:115], v[28:31], v[68:71], v[100:115]
    ds_read_b128 v[20:23], v1 offset:16384
    v_mul_f32 v52, v52, v134
    v_sub_f32 v52, v52, v133
    v_exp_f32 v52, v52
    v_mul_f32 v53, v53, v134
    v_sub_f32 v53, v53, v133
    v_exp_f32 v53, v53
    v_cvt_pk_bf16_f32 v75, v50, v51
    v_mul_f32 v54, v54, v134
    v_sub_f32 v54, v54, v133
    v_exp_f32 v54, v54
    v_mul_f32 v55, v55, v134
    v_sub_f32 v55, v55, v133
    v_exp_f32 v55, v55
    v_cvt_pk_bf16_f32 v76, v52, v53
    s_waitcnt lgkmcnt(1)
    v_mfma_f32_32x32x16_f16 v[36:51], v[4:7], v[84:87], 0
    ds_read_b128 v[24:27], v1 offset:17408
    v_mul_f32 v56, v56, v134
    v_sub_f32 v56, v56, v133
    v_exp_f32 v56, v56
    v_mul_f32 v57, v57, v134
    v_sub_f32 v57, v57, v133
    v_exp_f32 v57, v57
    v_cvt_pk_bf16_f32 v77, v54, v55
    v_mul_f32 v58, v58, v134
    v_sub_f32 v58, v58, v133
    v_exp_f32 v58, v58
    v_mul_f32 v59, v59, v134
    v_sub_f32 v59, v59, v133
    v_exp_f32 v59, v59
    v_cvt_pk_bf16_f32 v78, v56, v57
    v_mfma_f32_32x32x16_f16 v[36:51], v[8:11], v[92:95], v[36:51]
    ds_read_b128 v[12:15], v1 offset:2048
    v_mul_f32 v60, v60, v134
    v_sub_f32 v60, v60, v133
    v_exp_f32 v60, v60
    v_mul_f32 v61, v61, v134
    v_sub_f32 v61, v61, v133
    v_exp_f32 v61, v61
    v_cvt_pk_bf16_f32 v79, v58, v59
    v_mul_f32 v62, v62, v134
    v_sub_f32 v62, v62, v133
    v_exp_f32 v62, v62
    v_mul_f32 v63, v63, v134
    v_sub_f32 v63, v63, v133
    v_exp_f32 v63, v63
    v_cvt_pk_bf16_f32 v80, v60, v61
    v_mfma_f32_32x32x16_bf16 v[100:115], v[32:35], v[72:75], v[100:115]
    ds_read_b128 v[16:19], v1 offset:3072
    v_mul_f32 v64, v64, v134
    v_sub_f32 v64, v64, v133
    v_exp_f32 v64, v64
    v_mul_f32 v65, v65, v134
    v_sub_f32 v65, v65, v133
    v_exp_f32 v65, v65
    v_cvt_pk_bf16_f32 v81, v62, v63
    v_mul_f32 v66, v66, v134
    v_sub_f32 v66, v66, v133
    v_exp_f32 v66, v66
    v_mul_f32 v67, v67, v134
    v_sub_f32 v67, v67, v133
    v_exp_f32 v67, v67
    v_cvt_pk_bf16_f32 v82, v64, v65
    s_sub_u32 s33, s33, 1
    s_cmp_lg_u32 s33, 0
    s_cbranch_scc1 L_main_s
L_drain_s:
    v_cvt_pk_bf16_f32 v83, v66, v67
    s_nop 1
    v_mfma_f32_32x32x16_bf16 v[116:131], v[28:31], v[76:79], v[116:131]
    v_mfma_f32_32x32x16_bf16 v[116:131], v[32:35], v[80:83], v[116:131]
    s_branch L_epilogue
L_nobar_s7x:
.section .rodata,"a"
.p2align 6
.amdhsa_kernel standalone__qk_norm__prompt_kernel
  .amdhsa_next_free_vgpr 160
  .amdhsa_next_free_sgpr 100
  .amdhsa_accum_offset 160
  .amdhsa_group_segment_fixed_size 0
  .amdhsa_kernarg_size 56
  .amdhsa_user_sgpr_count 2
  .amdhsa_user_sgpr_kernarg_segment_ptr 1
  .amdhsa_system_sgpr_workgroup_id_x 1
.end_amdhsa_kernel
```
